```python
import torch

def _softmax(x, axis=-1):
    return torch.softmax(x, dim=axis)
def _gelu(x):
    return torch.nn.functional.gelu(x, approximate="tanh")
def _silu(x):
    return torch.nn.functional.silu(x)
def _sigmoid(x):
    return torch.sigmoid(x)
def _layernorm(x, axis=-1, eps=1e-5):
    m = x.mean(dim=axis, keepdim=True)
    v = x.var(dim=axis, keepdim=True, unbiased=False)
    return (x - m) / torch.sqrt(v + eps)
def _scatter_add(tgt, idx, src, axis=0):
    return tgt.clone().index_add_(axis, idx, src)
def _segment_sum(src, seg, n):
    out = torch.zeros((n,) + src.shape[1:], dtype=src.dtype)
    return out.index_add_(0, seg, src)
def _pad(x, pw):
    flat = tuple(v for pair in reversed(pw) for v in pair)
    return torch.nn.functional.pad(x, flat)

kernel_name = 'sequential_preLN__gqa_block_cached__glu_gated_bilinear__decode'

def setup_inputs():

    _w = (lambda a: (lambda t: t.to(torch.bfloat16) if t.is_floating_point() else t)(torch.as_tensor(a)))
    def _A_setup():
        B, Sq, D = 8, 1, 448
        Hq, Hkv, Sk, Dh = 16, 8, 8192, 256
        assert Hq % Hkv == 0, (Hq, Hkv)
        return {
            "x": _w((lambda *s: torch.randn(*s, dtype=torch.bfloat16) * 0.05)(B, Sq, D)),
            "k_cache": _w((lambda *s: torch.randn(*s, dtype=torch.bfloat16) * 1.6)(B, Hkv, Sk, Dh)),
            "v_cache": _w((lambda *s: torch.randn(*s, dtype=torch.bfloat16) * 0.8)(B, Hkv, Sk, Dh)),
            "wq": _w((lambda *s: torch.randn(*s, dtype=torch.bfloat16) * 1.6)(D, Hq * Dh) * (D ** -0.5)),
            "wo": _w((lambda *s: torch.randn(*s, dtype=torch.bfloat16) * 0.8)(Hq * Dh, D) * ((Hq * Dh) ** -0.5)),
        }
    _A_in = _A_setup()

    def _B_setup():
        B, S, D, F = 8, 1, 448, 1792
        return {
            "x": _w((lambda *s: torch.randn(*s, dtype=torch.bfloat16) * 0.05)(B, S, D)),
            "w_gate": _w((lambda *s: torch.randn(*s, dtype=torch.bfloat16) * 0.4)(D, F) * (D ** -0.5)),
            "w_up": _w((lambda *s: torch.randn(*s, dtype=torch.bfloat16) * 0.4)(D, F) * (D ** -0.5)),
            "w_down": _w((lambda *s: torch.randn(*s, dtype=torch.bfloat16) * 0.4)(F, D) * (F ** -0.5)),
        }
    _B_in = _B_setup()

    return {
        "A_x": _A_in["x"],
        "A_k_cache": _A_in["k_cache"],
        "A_v_cache": _A_in["v_cache"],
        "A_wq": _A_in["wq"],
        "A_wo": _A_in["wo"],
        "B_x": _B_in["x"],
        "B_w_gate": _B_in["w_gate"],
        "B_w_up": _B_in["w_up"],
        "B_w_down": _B_in["w_down"],
    }

def reference(A_x, A_k_cache, A_v_cache, A_wq, A_wo, B_x, B_w_gate, B_w_up, B_w_down):
    def _A_ref(x, k_cache, v_cache, wq, wo):
        B, Sq, D = x.shape
        Hq, Dh = 16, 256
        Hkv = k_cache.shape[1]
        rep = Hq // Hkv
        q = (lambda x, *d: x.permute(*d))((x @ wq).reshape(B, Sq, Hq, Dh), 0, 2, 1, 3)
        k = (lambda x, n, axis: torch.repeat_interleave(x, n, dim=axis))(k_cache, rep, axis=1)
        v = (lambda x, n, axis: torch.repeat_interleave(x, n, dim=axis))(v_cache, rep, axis=1)
        scores = torch.einsum("bhqd,bhkd->bhqk", q, k) * (Dh ** -0.5)
        p = _softmax(scores, axis=-1)
        o = torch.einsum("bhqk,bhkd->bhqd", p, v)
        return (lambda x, *d: x.permute(*d))(o, 0, 2, 1, 3).reshape(B, Sq, Hq * Dh) @ wo

    def _B_ref(x, w_gate, w_up, w_down):
        g = torch.einsum("bsd,df->bsf", x, w_gate)
        u = torch.einsum("bsd,df->bsf", x, w_up)
        h = g * u
        return torch.einsum("bsf,fd->bsd", h, w_down)

    x = A_x
    h = x + _A_ref(_layernorm(x, axis=-1), A_k_cache, A_v_cache, A_wq, A_wo)
    h2 = h + _B_ref(_layernorm(h, axis=-1), B_w_gate, B_w_up, B_w_down)
    return h2
```

```asm
; @launch grid=(256,1,1) block=(512,1,1) lds=163840
.amdgcn_target "amdgcn-amd-amdhsa--gfx950"
.text
.globl sequential_preLN__gqa_block_cached__glu_gated_bilinear__decode_kernel
.p2align 8
.type sequential_preLN__gqa_block_cached__glu_gated_bilinear__decode_kernel,@function
sequential_preLN__gqa_block_cached__glu_gated_bilinear__decode_kernel:
  s_cmp_ge_u32 s2, 256
  s_cbranch_scc1 L_end
  s_load_dwordx16 s[36:51], s[0:1], 0
  s_load_dwordx8 s[52:59], s[0:1], 64
  v_lshrrev_b32 v10, 6, v0
  v_and_b32 v1, 63, v0
  v_and_b32 v2, 15, v0
  v_bfe_u32 v3, v0, 4, 2
  v_readfirstlane_b32 s3, v10
  s_and_b32 s30, s2, 7
  s_lshr_b32 s33, s2, 3
  s_lshr_b32 s31, s2, 5
  s_and_b32 s32, s33, 3
  s_lshl_b32 s87, s30, 2
  s_add_u32 s87, s87, s32
  s_mov_b32 s34, 0x3db8aa3b
  s_mov_b32 s35, 0x05040100
  s_mov_b32 s60, 0x07060302
  s_mov_b32 s86, 0xffff0000
  s_mov_b32 s88, 0x100000
  s_mul_i32 s61, s30, 14
  s_lshl_b32 s80, s31, 1
  s_add_u32 s61, s61, s80
  s_add_u32 s61, s61, s32
  s_sub_u32 s61, s61, 1
  s_cmp_eq_u32 s31, 7
  s_cselect_b32 s61, 0xffff, s61
  s_cmp_eq_u32 s32, 0
  s_cselect_b32 s61, 0xffff, s61
  s_cmp_eq_u32 s32, 3
  s_cselect_b32 s61, 0xffff, s61
  s_mul_i32 s62, s30, 7
  s_add_u32 s62, s62, s31
  s_cmp_eq_u32 s31, 7
  s_cselect_b32 s62, 0xffff, s62
  s_cmp_lg_u32 s32, 0
  s_cselect_b32 s62, 0xffff, s62
  v_lshlrev_b32 v4, 9, v2
  v_lshl_add_u32 v4, v3, 4, v4
  v_add_u32 v5, 0x2000, v4
  v_lshlrev_b32 v6, 11, v3
  v_lshl_add_u32 v6, v2, 4, v6
  v_add_u32 v7, 0x2000, v6
  s_lshl_b32 s80, s31, 3
  s_add_u32 s80, s80, s30
  s_lshl_b32 s29, s80, 22
  s_lshl_b32 s81, s32, 20
  s_add_u32 s29, s29, s81
  s_lshl_b32 s81, s3, 14
  s_add_u32 s28, s29, s81
  s_lshl_b32 s83, s80, 8
  s_add_u32 s83, s83, 0x420000
  v_mov_b32 v10, 162816
  v_mov_b32 v16, 0
  v_mov_b32 v17, 0
  v_mov_b32 v18, 0
  v_mov_b32 v19, 0
  s_cmp_eq_u32 s3, 4
  s_cbranch_scc0 L_nz
  ds_write_b128 v10, v[16:19]
  ds_write_b128 v10, v[16:19] offset:16
  ds_write_b128 v10, v[16:19] offset:32
L_nz:
  s_waitcnt lgkmcnt(0)
  s_cmp_lt_u32 s3, 4
  s_cbranch_scc1 L_qphase
  s_mov_b32 s8, s38
  s_and_b32 s9, s39, 0xffff
  s_mov_b32 s10, 268435456
  s_mov_b32 s11, 0x20000
  s_mov_b32 s12, s40
  s_and_b32 s13, s41, 0xffff
  s_mov_b32 s14, 268435456
  s_mov_b32 s15, 0x20000
  s_mov_b32 s16, s58
  s_and_b32 s17, s59, 0xffff
  s_mov_b32 s18, 33554432
  s_mov_b32 s19, 0x20000
  s_setprio 2
  s_barrier
  buffer_load_dwordx4 v[128:131], v4, s[8:11], s28 offen offset:0 nt
  buffer_load_dwordx4 v[132:135], v4, s[8:11], s28 offen offset:64 nt
  buffer_load_dwordx4 v[136:139], v4, s[8:11], s28 offen offset:128 nt
  buffer_load_dwordx4 v[140:143], v4, s[8:11], s28 offen offset:192 nt
  buffer_load_dwordx4 v[144:147], v4, s[8:11], s28 offen offset:256 nt
  buffer_load_dwordx4 v[148:151], v4, s[8:11], s28 offen offset:320 nt
  buffer_load_dwordx4 v[152:155], v4, s[8:11], s28 offen offset:384 nt
  buffer_load_dwordx4 v[156:159], v4, s[8:11], s28 offen offset:448 nt
  buffer_load_dwordx4 v[160:163], v5, s[8:11], s28 offen offset:0 nt
  buffer_load_dwordx4 v[164:167], v5, s[8:11], s28 offen offset:64 nt
  buffer_load_dwordx4 v[168:171], v5, s[8:11], s28 offen offset:128 nt
  buffer_load_dwordx4 v[172:175], v5, s[8:11], s28 offen offset:192 nt
  buffer_load_dwordx4 v[176:179], v5, s[8:11], s28 offen offset:256 nt
  buffer_load_dwordx4 v[180:183], v5, s[8:11], s28 offen offset:320 nt
  buffer_load_dwordx4 v[184:187], v5, s[8:11], s28 offen offset:384 nt
  buffer_load_dwordx4 v[188:191], v5, s[8:11], s28 offen offset:448 nt
  buffer_load_dwordx4 v[192:195], v6, s[12:15], s28 offen offset:0 nt
  buffer_load_dwordx4 v[196:199], v6, s[12:15], s28 offen offset:512 nt
  buffer_load_dwordx4 v[200:203], v6, s[12:15], s28 offen offset:1024 nt
  buffer_load_dwordx4 v[204:207], v6, s[12:15], s28 offen offset:1536 nt
  buffer_load_dwordx4 v[208:211], v7, s[12:15], s28 offen offset:0 nt
  buffer_load_dwordx4 v[212:215], v7, s[12:15], s28 offen offset:512 nt
  buffer_load_dwordx4 v[216:219], v7, s[12:15], s28 offen offset:1024 nt
  buffer_load_dwordx4 v[220:223], v7, s[12:15], s28 offen offset:1536 nt
  buffer_load_dwordx4 v[224:227], v6, s[12:15], s28 offen offset:256 nt
  buffer_load_dwordx4 v[228:231], v6, s[12:15], s28 offen offset:768 nt
  buffer_load_dwordx4 v[232:235], v6, s[12:15], s28 offen offset:1280 nt
  buffer_load_dwordx4 v[236:239], v6, s[12:15], s28 offen offset:1792 nt
  buffer_load_dwordx4 v[240:243], v7, s[12:15], s28 offen offset:256 nt
  buffer_load_dwordx4 v[244:247], v7, s[12:15], s28 offen offset:768 nt
  buffer_load_dwordx4 v[248:251], v7, s[12:15], s28 offen offset:1280 nt
  buffer_load_dwordx4 v[252:255], v7, s[12:15], s28 offen offset:1792 nt
  s_setprio 0
  s_lshl_b32 s80, s2, 13
  s_add_u32 s80, s80, 0x100880
  s_add_u32 s82, s58, s80
  s_addc_u32 s83, s59, 0
  s_lshl_b32 s80, s31, 13
  s_lshl_b32 s81, s30, 10
  s_add_u32 s80, s80, s81
  s_lshl_b32 s81, s32, 16
  s_add_u32 s80, s80, s81
  s_sub_u32 s81, s3, 4
  s_lshl_b32 s81, s81, 8
  s_add_u32 s80, s80, s81
  s_add_u32 s84, s58, s80
  s_addc_u32 s85, s59, 0
  s_add_u32 s81, s81, 161792
  v_mov_b32 v12, s81
L_pq:
  s_load_dword s64, s[82:83], 0 glc
  s_waitcnt lgkmcnt(0)
  s_cmp_lg_u32 s64, -1
  s_cbranch_scc1 L_pq_ok
  s_sub_u32 s88, s88, 1
  s_cmp_eq_u32 s88, 0
  s_cbranch_scc1 L_end
  s_branch L_pq
L_pq_ok:
  s_load_dwordx16 s[64:79], s[84:85], 0 glc
  s_load_dwordx16 s[36:51], s[84:85], 64 glc
  s_waitcnt lgkmcnt(0)
  v_mov_b32 v16, s64
  v_mov_b32 v17, s65
  v_mov_b32 v18, s66
  v_mov_b32 v19, s67
  v_mov_b32 v20, s68
  v_mov_b32 v21, s69
  v_mov_b32 v22, s70
  v_mov_b32 v23, s71
  v_mov_b32 v24, s72
  v_mov_b32 v25, s73
  v_mov_b32 v26, s74
  v_mov_b32 v27, s75
  v_mov_b32 v28, s76
  v_mov_b32 v29, s77
  v_mov_b32 v30, s78
  v_mov_b32 v31, s79
  v_mov_b32 v32, s36
  v_mov_b32 v33, s37
  v_mov_b32 v34, s38
  v_mov_b32 v35, s39
  v_mov_b32 v36, s40
  v_mov_b32 v37, s41
  v_mov_b32 v38, s42
  v_mov_b32 v39, s43
  v_mov_b32 v40, s44
  v_mov_b32 v41, s45
  v_mov_b32 v42, s46
  v_mov_b32 v43, s47
  v_mov_b32 v44, s48
  v_mov_b32 v45, s49
  v_mov_b32 v46, s50
  v_mov_b32 v47, s51
  s_load_dwordx16 s[64:79], s[84:85], 128 glc
  s_load_dwordx16 s[36:51], s[84:85], 192 glc
  s_waitcnt lgkmcnt(0)
  v_mov_b32 v48, s64
  v_mov_b32 v49, s65
  v_mov_b32 v50, s66
  v_mov_b32 v51, s67
  v_mov_b32 v52, s68
  v_mov_b32 v53, s69
  v_mov_b32 v54, s70
  v_mov_b32 v55, s71
  v_mov_b32 v56, s72
  v_mov_b32 v57, s73
  v_mov_b32 v58, s74
  v_mov_b32 v59, s75
  v_mov_b32 v60, s76
  v_mov_b32 v61, s77
  v_mov_b32 v62, s78
  v_mov_b32 v63, s79
  v_mov_b32 v64, s36
  v_mov_b32 v65, s37
  v_mov_b32 v66, s38
  v_mov_b32 v67, s39
  v_mov_b32 v68, s40
  v_mov_b32 v69, s41
  v_mov_b32 v70, s42
  v_mov_b32 v71, s43
  v_mov_b32 v72, s44
  v_mov_b32 v73, s45
  v_mov_b32 v74, s46
  v_mov_b32 v75, s47
  v_mov_b32 v76, s48
  v_mov_b32 v77, s49
  v_mov_b32 v78, s50
  v_mov_b32 v79, s51
  s_load_dwordx16 s[36:51], s[0:1], 0
  s_mov_b64 exec, 1
  ds_write_b128 v12, v[16:19] offset:0
  ds_write_b128 v12, v[20:23] offset:16
  ds_write_b128 v12, v[24:27] offset:32
  ds_write_b128 v12, v[28:31] offset:48
  ds_write_b128 v12, v[32:35] offset:64
  ds_write_b128 v12, v[36:39] offset:80
  ds_write_b128 v12, v[40:43] offset:96
  ds_write_b128 v12, v[44:47] offset:112
  ds_write_b128 v12, v[48:51] offset:128
  ds_write_b128 v12, v[52:55] offset:144
  ds_write_b128 v12, v[56:59] offset:160
  ds_write_b128 v12, v[60:63] offset:176
  ds_write_b128 v12, v[64:67] offset:192
  ds_write_b128 v12, v[68:71] offset:208
  ds_write_b128 v12, v[72:75] offset:224
  ds_write_b128 v12, v[76:79] offset:240
  s_mov_b64 exec, -1
  s_waitcnt lgkmcnt(0)
  v_mov_b32 v10, 162816
  v_mov_b32 v11, 1
  s_mov_b64 exec, 1
  ds_add_u32 v10, v11 offset:12
  s_mov_b64 exec, -1
  s_mov_b32 s40, 256
  s_branch L_qwait
L_qphase:
  s_mov_b32 s8, s38
  s_and_b32 s9, s39, 0xffff
  s_mov_b32 s10, 268435456
  s_mov_b32 s11, 0x20000
  s_mov_b32 s12, s40
  s_and_b32 s13, s41, 0xffff
  s_mov_b32 s14, 268435456
  s_mov_b32 s15, 0x20000
  s_mov_b32 s20, s36
  s_and_b32 s21, s37, 0xffff
  s_mov_b32 s22, 7168
  s_mov_b32 s23, 0x20000
  s_mov_b32 s16, s58
  s_and_b32 s17, s59, 0xffff
  s_mov_b32 s18, 33554432
  s_mov_b32 s19, 0x20000
  s_add_u32 s41, s31, 4
  s_cmp_eq_u32 s32, 3
  s_cselect_b32 s41, s41, 99
  s_cmp_eq_u32 s31, 7
  s_cselect_b32 s41, s32, s41
  s_cmp_ge_u32 s41, 8
  s_cbranch_scc1 L_noq
  s_mov_b32 s24, s42
  s_and_b32 s25, s43, 0xffff
  s_mov_b32 s26, 3670016
  s_mov_b32 s27, 0x20000
  v_lshrrev_b32 v13, 3, v1
  v_lshlrev_b32 v13, 13, v13
  v_and_b32 v14, 7, v1
  v_lshl_add_u32 v13, v14, 4, v13
  s_lshl_b32 s80, s3, 20
  s_lshl_b32 s81, s30, 10
  s_add_u32 s80, s80, s81
  s_lshl_b32 s81, s41, 7
  s_add_u32 s80, s80, s81
  s_lshl_b32 s81, s3, 15
  s_mov_b32 m0, s81
  s_add_u32 s81, s81, 1024
  buffer_load_dwordx4 v13, s[24:27], s80 offen nt lds
  s_add_u32 s80, s80, 0x10000
  s_mov_b32 m0, s81
  s_add_u32 s81, s81, 1024
  buffer_load_dwordx4 v13, s[24:27], s80 offen nt lds
  s_add_u32 s80, s80, 0x10000
  s_mov_b32 m0, s81
  s_add_u32 s81, s81, 1024
  buffer_load_dwordx4 v13, s[24:27], s80 offen nt lds
  s_add_u32 s80, s80, 0x10000
  s_mov_b32 m0, s81
  s_add_u32 s81, s81, 1024
  buffer_load_dwordx4 v13, s[24:27], s80 offen nt lds
  s_add_u32 s80, s80, 0x10000
  s_mov_b32 m0, s81
  s_add_u32 s81, s81, 1024
  buffer_load_dwordx4 v13, s[24:27], s80 offen nt lds
  s_add_u32 s80, s80, 0x10000
  s_mov_b32 m0, s81
  s_add_u32 s81, s81, 1024
  buffer_load_dwordx4 v13, s[24:27], s80 offen nt lds
  s_add_u32 s80, s80, 0x10000
  s_mov_b32 m0, s81
  s_add_u32 s81, s81, 1024
  buffer_load_dwordx4 v13, s[24:27], s80 offen nt lds
  s_add_u32 s80, s80, 0x10000
  s_mov_b32 m0, s81
  s_add_u32 s81, s81, 1024
  buffer_load_dwordx4 v13, s[24:27], s80 offen nt lds
  s_add_u32 s80, s80, 0x10000
  s_mov_b32 m0, s81
  s_add_u32 s81, s81, 1024
  buffer_load_dwordx4 v13, s[24:27], s80 offen nt lds
  s_add_u32 s80, s80, 0x10000
  s_mov_b32 m0, s81
  s_add_u32 s81, s81, 1024
  buffer_load_dwordx4 v13, s[24:27], s80 offen nt lds
  s_add_u32 s80, s80, 0x10000
  s_mov_b32 m0, s81
  s_add_u32 s81, s81, 1024
  buffer_load_dwordx4 v13, s[24:27], s80 offen nt lds
  s_add_u32 s80, s80, 0x10000
  s_mov_b32 m0, s81
  s_add_u32 s81, s81, 1024
  buffer_load_dwordx4 v13, s[24:27], s80 offen nt lds
  s_add_u32 s80, s80, 0x10000
  s_mov_b32 m0, s81
  s_add_u32 s81, s81, 1024
  buffer_load_dwordx4 v13, s[24:27], s80 offen nt lds
  s_add_u32 s80, s80, 0x10000
  s_mov_b32 m0, s81
  s_add_u32 s81, s81, 1024
  buffer_load_dwordx4 v13, s[24:27], s80 offen nt lds
  s_add_u32 s80, s80, 0x10000
  s_mov_b32 m0, s81
  s_add_u32 s81, s81, 1024
  buffer_load_dwordx4 v13, s[24:27], s80 offen nt lds
  s_add_u32 s80, s80, 0x10000
  s_mov_b32 m0, s81
  s_add_u32 s81, s81, 1024
  buffer_load_dwordx4 v13, s[24:27], s80 offen nt lds
  s_add_u32 s80, s80, 0x10000
  v_and_b32 v10, 7, v1
  v_mul_u32_u24 v10, 896, v10
  v_lshrrev_b32 v11, 3, v1
  v_lshl_add_u32 v11, v11, 4, v10
  v_lshl_add_u32 v12, v3, 4, v10
  s_lshl_b32 s80, s3, 8
  buffer_load_dwordx4 v[16:19], v11, s[20:23], 0 offen offset:0
  buffer_load_dwordx4 v[20:23], v11, s[20:23], 0 offen offset:128
  buffer_load_dwordx4 v[24:27], v11, s[20:23], 0 offen offset:256
  buffer_load_dwordx4 v[28:31], v11, s[20:23], 0 offen offset:384
  buffer_load_dwordx4 v[32:35], v11, s[20:23], 0 offen offset:512
  buffer_load_dwordx4 v[36:39], v11, s[20:23], 0 offen offset:640
  buffer_load_dwordx4 v[40:43], v11, s[20:23], 0 offen offset:768
  buffer_load_dwordx4 v[44:47], v12, s[20:23], s80 offen offset:0
  buffer_load_dwordx4 v[48:51], v12, s[20:23], s80 offen offset:64
  buffer_load_dwordx4 v[52:55], v12, s[20:23], s80 offen offset:128
  buffer_load_dwordx4 v[56:59], v12, s[20:23], s80 offen offset:192
L_noq:
  s_mul_i32 s80, s31, 896
  s_mul_i32 s81, s87, 28
  s_add_u32 s80, s80, s81
  v_lshlrev_b32 v15, 1, v2
  buffer_load_ushort v68, v15, s[20:23], s80 offen
  v_mov_b32 v124, -1
  v_mov_b32 v125, -1
  v_mov_b32 v126, -1
  v_mov_b32 v127, -1
  v_lshlrev_b32 v10, 4, v0
  s_lshl_b32 s80, s2, 13
  s_add_u32 s80, s80, 0x100000
  buffer_store_dwordx4 v[124:127], v10, s[16:19], s80 offen sc1
  s_cmp_eq_u32 s3, 3
  s_cbranch_scc0 L_noclr
  s_add_u32 s80, s80, 4096
  s_lshl_b32 s81, s2, 7
  s_add_u32 s81, s81, 0x40ff00
  s_lshl_b32 s82, s2, 5
  s_add_u32 s82, s82, 0x3ffe80
  v_mov_b32 v11, s80
  v_mov_b32 v12, s81
  v_cmp_lt_u32 vcc, 15, v1
  v_mov_b32 v13, s82
  s_nop 0
  v_cndmask_b32 v11, v11, v12, vcc
  v_cmp_lt_u32 vcc, 23, v1
  v_lshlrev_b32 v10, 4, v1
  s_nop 0
  v_cndmask_b32 v11, v11, v13, vcc
  v_add_u32 v11, v11, v10
  s_mov_b64 exec, 0x3ffffff
  buffer_store_dwordx4 v[124:127], v11, s[16:19], 0 offen sc1
  s_mov_b64 exec, -1
L_noclr:
  s_barrier
  s_cmp_ge_u32 s41, 8
  s_cbranch_scc0 L_prod
  buffer_load_dwordx4 v[128:131], v4, s[8:11], s28 offen offset:0 nt
  buffer_load_dwordx4 v[132:135], v4, s[8:11], s28 offen offset:64 nt
  buffer_load_dwordx4 v[136:139], v4, s[8:11], s28 offen offset:128 nt
  buffer_load_dwordx4 v[140:143], v4, s[8:11], s28 offen offset:192 nt
  buffer_load_dwordx4 v[144:147], v4, s[8:11], s28 offen offset:256 nt
  buffer_load_dwordx4 v[148:151], v4, s[8:11], s28 offen offset:320 nt
  buffer_load_dwordx4 v[152:155], v4, s[8:11], s28 offen offset:384 nt
  buffer_load_dwordx4 v[156:159], v4, s[8:11], s28 offen offset:448 nt
  s_waitcnt vmcnt(8)
  v_mov_b32 v10, 162816
  v_mov_b32 v11, 1
  s_mov_b64 exec, 1
  ds_add_u32 v10, v11 offset:4
  s_mov_b64 exec, -1
  s_cmp_eq_u32 s3, 0
  s_cbranch_scc0 L_pf2
  s_mov_b32 s40, 1
  s_branch L_arrive
L_prod:
  v_lshlrev_b32 v104, 10, v3
  v_bfe_u32 v10, v1, 2, 2
  v_lshl_add_u32 v104, v10, 7, v104
  v_and_b32 v10, 3, v1
  v_lshl_add_u32 v104, v10, 3, v104
  s_lshl_b32 s81, s3, 15
  v_add_u32 v104, s81, v104
  s_setprio 3
  s_waitcnt vmcnt(6)
  ds_read_b64_tr_b16 v[128:129], v104 offset:0
  ds_read_b64_tr_b16 v[130:131], v104 offset:512
  ds_read_b64_tr_b16 v[132:133], v104 offset:32
  ds_read_b64_tr_b16 v[134:135], v104 offset:544
  ds_read_b64_tr_b16 v[136:137], v104 offset:64
  ds_read_b64_tr_b16 v[138:139], v104 offset:576
  ds_read_b64_tr_b16 v[140:141], v104 offset:96
  ds_read_b64_tr_b16 v[142:143], v104 offset:608
  ds_read_b64_tr_b16 v[144:145], v104 offset:4096
  ds_read_b64_tr_b16 v[146:147], v104 offset:4608
  ds_read_b64_tr_b16 v[148:149], v104 offset:4128
  ds_read_b64_tr_b16 v[150:151], v104 offset:4640
  ds_read_b64_tr_b16 v[152:153], v104 offset:4160
  ds_read_b64_tr_b16 v[154:155], v104 offset:4672
  ds_read_b64_tr_b16 v[156:157], v104 offset:4192
  ds_read_b64_tr_b16 v[158:159], v104 offset:4704
  ds_read_b64_tr_b16 v[160:161], v104 offset:8192
  ds_read_b64_tr_b16 v[162:163], v104 offset:8704
  ds_read_b64_tr_b16 v[164:165], v104 offset:8224
  ds_read_b64_tr_b16 v[166:167], v104 offset:8736
  ds_read_b64_tr_b16 v[168:169], v104 offset:8256
  ds_read_b64_tr_b16 v[170:171], v104 offset:8768
  ds_read_b64_tr_b16 v[172:173], v104 offset:8288
  ds_read_b64_tr_b16 v[174:175], v104 offset:8800
  ds_read_b64_tr_b16 v[176:177], v104 offset:12288
  ds_read_b64_tr_b16 v[178:179], v104 offset:12800
  ds_read_b64_tr_b16 v[180:181], v104 offset:12320
  ds_read_b64_tr_b16 v[182:183], v104 offset:12832
  ds_read_b64_tr_b16 v[184:185], v104 offset:12352
  ds_read_b64_tr_b16 v[186:187], v104 offset:12864
  ds_read_b64_tr_b16 v[188:189], v104 offset:12384
  ds_read_b64_tr_b16 v[190:191], v104 offset:12896
  v_lshlrev_b32 v10, 16, v16
  v_and_b32 v11, s86, v16
  v_lshlrev_b32 v12, 16, v17
  v_and_b32 v13, s86, v17
  v_lshlrev_b32 v96, 16, v18
  v_and_b32 v97, s86, v18
  v_pk_add_f32 v[10:11], v[10:11], v[96:97]
  v_lshlrev_b32 v98, 16, v19
  v_and_b32 v99, s86, v19
  v_pk_add_f32 v[12:13], v[12:13], v[98:99]
  v_lshlrev_b32 v96, 16, v20
  v_and_b32 v97, s86, v20
  v_pk_add_f32 v[10:11], v[10:11], v[96:97]
  v_lshlrev_b32 v98, 16, v21
  v_and_b32 v99, s86, v21
  v_pk_add_f32 v[12:13], v[12:13], v[98:99]
  v_lshlrev_b32 v96, 16, v22
  v_and_b32 v97, s86, v22
  v_pk_add_f32 v[10:11], v[10:11], v[96:97]
  v_lshlrev_b32 v98, 16, v23
  v_and_b32 v99, s86, v23
  v_pk_add_f32 v[12:13], v[12:13], v[98:99]
  v_lshlrev_b32 v96, 16, v24
  v_and_b32 v97, s86, v24
  v_pk_add_f32 v[10:11], v[10:11], v[96:97]
  v_lshlrev_b32 v98, 16, v25
  v_and_b32 v99, s86, v25
  v_pk_add_f32 v[12:13], v[12:13], v[98:99]
  v_lshlrev_b32 v96, 16, v26
  v_and_b32 v97, s86, v26
  v_pk_add_f32 v[10:11], v[10:11], v[96:97]
  v_lshlrev_b32 v98, 16, v27
  v_and_b32 v99, s86, v27
  v_pk_add_f32 v[12:13], v[12:13], v[98:99]
  v_lshlrev_b32 v96, 16, v28
  v_and_b32 v97, s86, v28
  v_pk_add_f32 v[10:11], v[10:11], v[96:97]
  v_lshlrev_b32 v98, 16, v29
  v_and_b32 v99, s86, v29
  v_pk_add_f32 v[12:13], v[12:13], v[98:99]
  v_lshlrev_b32 v96, 16, v30
  v_and_b32 v97, s86, v30
  v_pk_add_f32 v[10:11], v[10:11], v[96:97]
  v_lshlrev_b32 v98, 16, v31
  v_and_b32 v99, s86, v31
  v_pk_add_f32 v[12:13], v[12:13], v[98:99]
  v_lshlrev_b32 v96, 16, v32
  v_and_b32 v97, s86, v32
  v_pk_add_f32 v[10:11], v[10:11], v[96:97]
  v_lshlrev_b32 v98, 16, v33
  v_and_b32 v99, s86, v33
  v_pk_add_f32 v[12:13], v[12:13], v[98:99]
  v_lshlrev_b32 v96, 16, v34
  v_and_b32 v97, s86, v34
  v_pk_add_f32 v[10:11], v[10:11], v[96:97]
  v_lshlrev_b32 v98, 16, v35
  v_and_b32 v99, s86, v35
  v_pk_add_f32 v[12:13], v[12:13], v[98:99]
  v_lshlrev_b32 v96, 16, v36
  v_and_b32 v97, s86, v36
  v_pk_add_f32 v[10:11], v[10:11], v[96:97]
  v_lshlrev_b32 v98, 16, v37
  v_and_b32 v99, s86, v37
  v_pk_add_f32 v[12:13], v[12:13], v[98:99]
  v_lshlrev_b32 v96, 16, v38
  v_and_b32 v97, s86, v38
  v_pk_add_f32 v[10:11], v[10:11], v[96:97]
  v_lshlrev_b32 v98, 16, v39
  v_and_b32 v99, s86, v39
  v_pk_add_f32 v[12:13], v[12:13], v[98:99]
  v_lshlrev_b32 v96, 16, v40
  v_and_b32 v97, s86, v40
  v_pk_add_f32 v[10:11], v[10:11], v[96:97]
  v_lshlrev_b32 v98, 16, v41
  v_and_b32 v99, s86, v41
  v_pk_add_f32 v[12:13], v[12:13], v[98:99]
  v_lshlrev_b32 v96, 16, v42
  v_and_b32 v97, s86, v42
  v_pk_add_f32 v[10:11], v[10:11], v[96:97]
  v_lshlrev_b32 v98, 16, v43
  v_and_b32 v99, s86, v43
  v_pk_add_f32 v[12:13], v[12:13], v[98:99]
  v_pk_add_f32 v[10:11], v[10:11], v[12:13]
  v_add_f32 v10, v10, v11
  s_nop 1
  v_add_f32_dpp v10, v10, v10 row_ror:8 row_mask:0xf bank_mask:0xf
  v_mov_b32 v11, v10
  s_nop 1
  v_permlane16_swap_b32 v10, v11
  s_nop 0
  v_add_f32 v10, v10, v11
  v_mov_b32 v11, v10
  s_nop 1
  v_permlane32_swap_b32 v10, v11
  s_nop 0
  v_add_f32 v10, v10, v11
  v_mul_f32 v14, 0x3b124925, v10
  v_mul_f32 v15, 0x3b124925, v10
  v_mov_b32 v10, 0
  v_mov_b32 v11, 0
  v_mov_b32 v12, 0
  v_mov_b32 v13, 0
  v_lshlrev_b32 v96, 16, v16
  v_and_b32 v97, s86, v16
  v_pk_add_f32 v[96:97], v[96:97], v[14:15] neg_lo:[0,1] neg_hi:[0,1]
  v_pk_fma_f32 v[10:11], v[96:97], v[96:97], v[10:11]
  v_lshlrev_b32 v98, 16, v17
  v_and_b32 v99, s86, v17
  v_pk_add_f32 v[98:99], v[98:99], v[14:15] neg_lo:[0,1] neg_hi:[0,1]
  v_pk_fma_f32 v[12:13], v[98:99], v[98:99], v[12:13]
  v_lshlrev_b32 v96, 16, v18
  v_and_b32 v97, s86, v18
  v_pk_add_f32 v[96:97], v[96:97], v[14:15] neg_lo:[0,1] neg_hi:[0,1]
  v_pk_fma_f32 v[10:11], v[96:97], v[96:97], v[10:11]
  v_lshlrev_b32 v98, 16, v19
  v_and_b32 v99, s86, v19
  v_pk_add_f32 v[98:99], v[98:99], v[14:15] neg_lo:[0,1] neg_hi:[0,1]
  v_pk_fma_f32 v[12:13], v[98:99], v[98:99], v[12:13]
  v_lshlrev_b32 v96, 16, v20
  v_and_b32 v97, s86, v20
  v_pk_add_f32 v[96:97], v[96:97], v[14:15] neg_lo:[0,1] neg_hi:[0,1]
  v_pk_fma_f32 v[10:11], v[96:97], v[96:97], v[10:11]
  v_lshlrev_b32 v98, 16, v21
  v_and_b32 v99, s86, v21
  v_pk_add_f32 v[98:99], v[98:99], v[14:15] neg_lo:[0,1] neg_hi:[0,1]
  v_pk_fma_f32 v[12:13], v[98:99], v[98:99], v[12:13]
  v_lshlrev_b32 v96, 16, v22
  v_and_b32 v97, s86, v22
  v_pk_add_f32 v[96:97], v[96:97], v[14:15] neg_lo:[0,1] neg_hi:[0,1]
  v_pk_fma_f32 v[10:11], v[96:97], v[96:97], v[10:11]
  v_lshlrev_b32 v98, 16, v23
  v_and_b32 v99, s86, v23
  v_pk_add_f32 v[98:99], v[98:99], v[14:15] neg_lo:[0,1] neg_hi:[0,1]
  v_pk_fma_f32 v[12:13], v[98:99], v[98:99], v[12:13]
  v_lshlrev_b32 v96, 16, v24
  v_and_b32 v97, s86, v24
  v_pk_add_f32 v[96:97], v[96:97], v[14:15] neg_lo:[0,1] neg_hi:[0,1]
  v_pk_fma_f32 v[10:11], v[96:97], v[96:97], v[10:11]
  v_lshlrev_b32 v98, 16, v25
  v_and_b32 v99, s86, v25
  v_pk_add_f32 v[98:99], v[98:99], v[14:15] neg_lo:[0,1] neg_hi:[0,1]
  v_pk_fma_f32 v[12:13], v[98:99], v[98:99], v[12:13]
  v_lshlrev_b32 v96, 16, v26
  v_and_b32 v97, s86, v26
  v_pk_add_f32 v[96:97], v[96:97], v[14:15] neg_lo:[0,1] neg_hi:[0,1]
  v_pk_fma_f32 v[10:11], v[96:97], v[96:97], v[10:11]
  v_lshlrev_b32 v98, 16, v27
  v_and_b32 v99, s86, v27
  v_pk_add_f32 v[98:99], v[98:99], v[14:15] neg_lo:[0,1] neg_hi:[0,1]
  v_pk_fma_f32 v[12:13], v[98:99], v[98:99], v[12:13]
  v_lshlrev_b32 v96, 16, v28
  v_and_b32 v97, s86, v28
  v_pk_add_f32 v[96:97], v[96:97], v[14:15] neg_lo:[0,1] neg_hi:[0,1]
  v_pk_fma_f32 v[10:11], v[96:97], v[96:97], v[10:11]
  v_lshlrev_b32 v98, 16, v29
  v_and_b32 v99, s86, v29
  v_pk_add_f32 v[98:99], v[98:99], v[14:15] neg_lo:[0,1] neg_hi:[0,1]
  v_pk_fma_f32 v[12:13], v[98:99], v[98:99], v[12:13]
  v_lshlrev_b32 v96, 16, v30
  v_and_b32 v97, s86, v30
  v_pk_add_f32 v[96:97], v[96:97], v[14:15] neg_lo:[0,1] neg_hi:[0,1]
  v_pk_fma_f32 v[10:11], v[96:97], v[96:97], v[10:11]
  v_lshlrev_b32 v98, 16, v31
  v_and_b32 v99, s86, v31
  v_pk_add_f32 v[98:99], v[98:99], v[14:15] neg_lo:[0,1] neg_hi:[0,1]
  v_pk_fma_f32 v[12:13], v[98:99], v[98:99], v[12:13]
  v_lshlrev_b32 v96, 16, v32
  v_and_b32 v97, s86, v32
  v_pk_add_f32 v[96:97], v[96:97], v[14:15] neg_lo:[0,1] neg_hi:[0,1]
  v_pk_fma_f32 v[10:11], v[96:97], v[96:97], v[10:11]
  v_lshlrev_b32 v98, 16, v33
  v_and_b32 v99, s86, v33
  v_pk_add_f32 v[98:99], v[98:99], v[14:15] neg_lo:[0,1] neg_hi:[0,1]
  v_pk_fma_f32 v[12:13], v[98:99], v[98:99], v[12:13]
  v_lshlrev_b32 v96, 16, v34
  v_and_b32 v97, s86, v34
  v_pk_add_f32 v[96:97], v[96:97], v[14:15] neg_lo:[0,1] neg_hi:[0,1]
  v_pk_fma_f32 v[10:11], v[96:97], v[96:97], v[10:11]
  v_lshlrev_b32 v98, 16, v35
  v_and_b32 v99, s86, v35
  v_pk_add_f32 v[98:99], v[98:99], v[14:15] neg_lo:[0,1] neg_hi:[0,1]
  v_pk_fma_f32 v[12:13], v[98:99], v[98:99], v[12:13]
  v_lshlrev_b32 v96, 16, v36
  v_and_b32 v97, s86, v36
  v_pk_add_f32 v[96:97], v[96:97], v[14:15] neg_lo:[0,1] neg_hi:[0,1]
  v_pk_fma_f32 v[10:11], v[96:97], v[96:97], v[10:11]
  v_lshlrev_b32 v98, 16, v37
  v_and_b32 v99, s86, v37
  v_pk_add_f32 v[98:99], v[98:99], v[14:15] neg_lo:[0,1] neg_hi:[0,1]
  v_pk_fma_f32 v[12:13], v[98:99], v[98:99], v[12:13]
  v_lshlrev_b32 v96, 16, v38
  v_and_b32 v97, s86, v38
  v_pk_add_f32 v[96:97], v[96:97], v[14:15] neg_lo:[0,1] neg_hi:[0,1]
  v_pk_fma_f32 v[10:11], v[96:97], v[96:97], v[10:11]
  v_lshlrev_b32 v98, 16, v39
  v_and_b32 v99, s86, v39
  v_pk_add_f32 v[98:99], v[98:99], v[14:15] neg_lo:[0,1] neg_hi:[0,1]
  v_pk_fma_f32 v[12:13], v[98:99], v[98:99], v[12:13]
  v_lshlrev_b32 v96, 16, v40
  v_and_b32 v97, s86, v40
  v_pk_add_f32 v[96:97], v[96:97], v[14:15] neg_lo:[0,1] neg_hi:[0,1]
  v_pk_fma_f32 v[10:11], v[96:97], v[96:97], v[10:11]
  v_lshlrev_b32 v98, 16, v41
  v_and_b32 v99, s86, v41
  v_pk_add_f32 v[98:99], v[98:99], v[14:15] neg_lo:[0,1] neg_hi:[0,1]
  v_pk_fma_f32 v[12:13], v[98:99], v[98:99], v[12:13]
  v_lshlrev_b32 v96, 16, v42
  v_and_b32 v97, s86, v42
  v_pk_add_f32 v[96:97], v[96:97], v[14:15] neg_lo:[0,1] neg_hi:[0,1]
  v_pk_fma_f32 v[10:11], v[96:97], v[96:97], v[10:11]
  v_lshlrev_b32 v98, 16, v43
  v_and_b32 v99, s86, v43
  v_pk_add_f32 v[98:99], v[98:99], v[14:15] neg_lo:[0,1] neg_hi:[0,1]
  v_pk_fma_f32 v[12:13], v[98:99], v[98:99], v[12:13]
  v_pk_add_f32 v[10:11], v[10:11], v[12:13]
  v_add_f32 v10, v10, v11
  s_nop 1
  v_add_f32_dpp v10, v10, v10 row_ror:8 row_mask:0xf bank_mask:0xf
  v_mov_b32 v11, v10
  s_nop 1
  v_permlane16_swap_b32 v10, v11
  s_nop 0
  v_add_f32 v10, v10, v11
  v_mov_b32 v11, v10
  s_nop 1
  v_permlane32_swap_b32 v10, v11
  s_nop 0
  v_add_f32 v10, v10, v11
  v_mul_f32 v10, 0x3b124925, v10
  v_cvt_pk_bf16_f32 v10, v10, v10
  v_lshlrev_b32 v10, 16, v10
  v_add_f32 v10, 0x3727c5ac, v10
  v_cvt_pk_bf16_f32 v10, v10, v10
  v_lshlrev_b32 v10, 16, v10
  v_sqrt_f32 v10, v10
  v_cvt_pk_bf16_f32 v14, v14, v14
  v_lshlrev_b32 v14, 16, v14
  v_cvt_pk_bf16_f32 v10, v10, v10
  v_lshlrev_b32 v10, 16, v10
  v_rcp_f32 v12, v10
  v_mov_b32 v15, v14
  v_mov_b32 v11, v10
  v_mov_b32 v13, v12
  s_waitcnt vmcnt(1)
  v_lshlrev_b32 v96, 16, v44
  v_and_b32 v97, s86, v44
  v_pk_add_f32 v[96:97], v[96:97], v[14:15] neg_lo:[0,1] neg_hi:[0,1]
  v_cvt_pk_bf16_f32 v97, v96, v97
  v_lshlrev_b32 v96, 16, v97
  v_and_b32 v97, s86, v97
  v_pk_mul_f32 v[98:99], v[96:97], v[12:13]
  v_pk_fma_f32 v[100:101], v[98:99], v[10:11], v[96:97] neg_lo:[1,0,0] neg_hi:[1,0,0]
  v_pk_fma_f32 v[98:99], v[100:101], v[12:13], v[98:99]
  v_cvt_pk_bf16_f32 v44, v98, v99
  v_lshlrev_b32 v96, 16, v45
  v_and_b32 v97, s86, v45
  v_pk_add_f32 v[96:97], v[96:97], v[14:15] neg_lo:[0,1] neg_hi:[0,1]
  v_cvt_pk_bf16_f32 v97, v96, v97
  v_lshlrev_b32 v96, 16, v97
  v_and_b32 v97, s86, v97
  v_pk_mul_f32 v[98:99], v[96:97], v[12:13]
  v_pk_fma_f32 v[100:101], v[98:99], v[10:11], v[96:97] neg_lo:[1,0,0] neg_hi:[1,0,0]
  v_pk_fma_f32 v[98:99], v[100:101], v[12:13], v[98:99]
  v_cvt_pk_bf16_f32 v45, v98, v99
  v_lshlrev_b32 v96, 16, v46
  v_and_b32 v97, s86, v46
  v_pk_add_f32 v[96:97], v[96:97], v[14:15] neg_lo:[0,1] neg_hi:[0,1]
  v_cvt_pk_bf16_f32 v97, v96, v97
  v_lshlrev_b32 v96, 16, v97
  v_and_b32 v97, s86, v97
  v_pk_mul_f32 v[98:99], v[96:97], v[12:13]
  v_pk_fma_f32 v[100:101], v[98:99], v[10:11], v[96:97] neg_lo:[1,0,0] neg_hi:[1,0,0]
  v_pk_fma_f32 v[98:99], v[100:101], v[12:13], v[98:99]
  v_cvt_pk_bf16_f32 v46, v98, v99
  v_lshlrev_b32 v96, 16, v47
  v_and_b32 v97, s86, v47
  v_pk_add_f32 v[96:97], v[96:97], v[14:15] neg_lo:[0,1] neg_hi:[0,1]
  v_cvt_pk_bf16_f32 v97, v96, v97
  v_lshlrev_b32 v96, 16, v97
  v_and_b32 v97, s86, v97
  v_pk_mul_f32 v[98:99], v[96:97], v[12:13]
  v_pk_fma_f32 v[100:101], v[98:99], v[10:11], v[96:97] neg_lo:[1,0,0] neg_hi:[1,0,0]
  v_pk_fma_f32 v[98:99], v[100:101], v[12:13], v[98:99]
  v_cvt_pk_bf16_f32 v47, v98, v99
  v_lshlrev_b32 v96, 16, v48
  v_and_b32 v97, s86, v48
  v_pk_add_f32 v[96:97], v[96:97], v[14:15] neg_lo:[0,1] neg_hi:[0,1]
  v_cvt_pk_bf16_f32 v97, v96, v97
  v_lshlrev_b32 v96, 16, v97
  v_and_b32 v97, s86, v97
  v_pk_mul_f32 v[98:99], v[96:97], v[12:13]
  v_pk_fma_f32 v[100:101], v[98:99], v[10:11], v[96:97] neg_lo:[1,0,0] neg_hi:[1,0,0]
  v_pk_fma_f32 v[98:99], v[100:101], v[12:13], v[98:99]
  v_cvt_pk_bf16_f32 v48, v98, v99
  v_lshlrev_b32 v96, 16, v49
  v_and_b32 v97, s86, v49
  v_pk_add_f32 v[96:97], v[96:97], v[14:15] neg_lo:[0,1] neg_hi:[0,1]
  v_cvt_pk_bf16_f32 v97, v96, v97
  v_lshlrev_b32 v96, 16, v97
  v_and_b32 v97, s86, v97
  v_pk_mul_f32 v[98:99], v[96:97], v[12:13]
  v_pk_fma_f32 v[100:101], v[98:99], v[10:11], v[96:97] neg_lo:[1,0,0] neg_hi:[1,0,0]
  v_pk_fma_f32 v[98:99], v[100:101], v[12:13], v[98:99]
  v_cvt_pk_bf16_f32 v49, v98, v99
  v_lshlrev_b32 v96, 16, v50
  v_and_b32 v97, s86, v50
  v_pk_add_f32 v[96:97], v[96:97], v[14:15] neg_lo:[0,1] neg_hi:[0,1]
  v_cvt_pk_bf16_f32 v97, v96, v97
  v_lshlrev_b32 v96, 16, v97
  v_and_b32 v97, s86, v97
  v_pk_mul_f32 v[98:99], v[96:97], v[12:13]
  v_pk_fma_f32 v[100:101], v[98:99], v[10:11], v[96:97] neg_lo:[1,0,0] neg_hi:[1,0,0]
  v_pk_fma_f32 v[98:99], v[100:101], v[12:13], v[98:99]
  v_cvt_pk_bf16_f32 v50, v98, v99
  v_lshlrev_b32 v96, 16, v51
  v_and_b32 v97, s86, v51
  v_pk_add_f32 v[96:97], v[96:97], v[14:15] neg_lo:[0,1] neg_hi:[0,1]
  v_cvt_pk_bf16_f32 v97, v96, v97
  v_lshlrev_b32 v96, 16, v97
  v_and_b32 v97, s86, v97
  v_pk_mul_f32 v[98:99], v[96:97], v[12:13]
  v_pk_fma_f32 v[100:101], v[98:99], v[10:11], v[96:97] neg_lo:[1,0,0] neg_hi:[1,0,0]
  v_pk_fma_f32 v[98:99], v[100:101], v[12:13], v[98:99]
  v_cvt_pk_bf16_f32 v51, v98, v99
  v_lshlrev_b32 v96, 16, v52
  v_and_b32 v97, s86, v52
  v_pk_add_f32 v[96:97], v[96:97], v[14:15] neg_lo:[0,1] neg_hi:[0,1]
  v_cvt_pk_bf16_f32 v97, v96, v97
  v_lshlrev_b32 v96, 16, v97
  v_and_b32 v97, s86, v97
  v_pk_mul_f32 v[98:99], v[96:97], v[12:13]
  v_pk_fma_f32 v[100:101], v[98:99], v[10:11], v[96:97] neg_lo:[1,0,0] neg_hi:[1,0,0]
  v_pk_fma_f32 v[98:99], v[100:101], v[12:13], v[98:99]
  v_cvt_pk_bf16_f32 v52, v98, v99
  v_lshlrev_b32 v96, 16, v53
  v_and_b32 v97, s86, v53
  v_pk_add_f32 v[96:97], v[96:97], v[14:15] neg_lo:[0,1] neg_hi:[0,1]
  v_cvt_pk_bf16_f32 v97, v96, v97
  v_lshlrev_b32 v96, 16, v97
  v_and_b32 v97, s86, v97
  v_pk_mul_f32 v[98:99], v[96:97], v[12:13]
  v_pk_fma_f32 v[100:101], v[98:99], v[10:11], v[96:97] neg_lo:[1,0,0] neg_hi:[1,0,0]
  v_pk_fma_f32 v[98:99], v[100:101], v[12:13], v[98:99]
  v_cvt_pk_bf16_f32 v53, v98, v99
  v_lshlrev_b32 v96, 16, v54
  v_and_b32 v97, s86, v54
  v_pk_add_f32 v[96:97], v[96:97], v[14:15] neg_lo:[0,1] neg_hi:[0,1]
  v_cvt_pk_bf16_f32 v97, v96, v97
  v_lshlrev_b32 v96, 16, v97
  v_and_b32 v97, s86, v97
  v_pk_mul_f32 v[98:99], v[96:97], v[12:13]
  v_pk_fma_f32 v[100:101], v[98:99], v[10:11], v[96:97] neg_lo:[1,0,0] neg_hi:[1,0,0]
  v_pk_fma_f32 v[98:99], v[100:101], v[12:13], v[98:99]
  v_cvt_pk_bf16_f32 v54, v98, v99
  v_lshlrev_b32 v96, 16, v55
  v_and_b32 v97, s86, v55
  v_pk_add_f32 v[96:97], v[96:97], v[14:15] neg_lo:[0,1] neg_hi:[0,1]
  v_cvt_pk_bf16_f32 v97, v96, v97
  v_lshlrev_b32 v96, 16, v97
  v_and_b32 v97, s86, v97
  v_pk_mul_f32 v[98:99], v[96:97], v[12:13]
  v_pk_fma_f32 v[100:101], v[98:99], v[10:11], v[96:97] neg_lo:[1,0,0] neg_hi:[1,0,0]
  v_pk_fma_f32 v[98:99], v[100:101], v[12:13], v[98:99]
  v_cvt_pk_bf16_f32 v55, v98, v99
  v_lshlrev_b32 v96, 16, v56
  v_and_b32 v97, s86, v56
  v_pk_add_f32 v[96:97], v[96:97], v[14:15] neg_lo:[0,1] neg_hi:[0,1]
  v_cvt_pk_bf16_f32 v97, v96, v97
  v_lshlrev_b32 v96, 16, v97
  v_and_b32 v97, s86, v97
  v_pk_mul_f32 v[98:99], v[96:97], v[12:13]
  v_pk_fma_f32 v[100:101], v[98:99], v[10:11], v[96:97] neg_lo:[1,0,0] neg_hi:[1,0,0]
  v_pk_fma_f32 v[98:99], v[100:101], v[12:13], v[98:99]
  v_cvt_pk_bf16_f32 v56, v98, v99
  v_lshlrev_b32 v96, 16, v57
  v_and_b32 v97, s86, v57
  v_pk_add_f32 v[96:97], v[96:97], v[14:15] neg_lo:[0,1] neg_hi:[0,1]
  v_cvt_pk_bf16_f32 v97, v96, v97
  v_lshlrev_b32 v96, 16, v97
  v_and_b32 v97, s86, v97
  v_pk_mul_f32 v[98:99], v[96:97], v[12:13]
  v_pk_fma_f32 v[100:101], v[98:99], v[10:11], v[96:97] neg_lo:[1,0,0] neg_hi:[1,0,0]
  v_pk_fma_f32 v[98:99], v[100:101], v[12:13], v[98:99]
  v_cvt_pk_bf16_f32 v57, v98, v99
  v_lshlrev_b32 v96, 16, v58
  v_and_b32 v97, s86, v58
  v_pk_add_f32 v[96:97], v[96:97], v[14:15] neg_lo:[0,1] neg_hi:[0,1]
  v_cvt_pk_bf16_f32 v97, v96, v97
  v_lshlrev_b32 v96, 16, v97
  v_and_b32 v97, s86, v97
  v_pk_mul_f32 v[98:99], v[96:97], v[12:13]
  v_pk_fma_f32 v[100:101], v[98:99], v[10:11], v[96:97] neg_lo:[1,0,0] neg_hi:[1,0,0]
  v_pk_fma_f32 v[98:99], v[100:101], v[12:13], v[98:99]
  v_cvt_pk_bf16_f32 v58, v98, v99
  v_lshlrev_b32 v96, 16, v59
  v_and_b32 v97, s86, v59
  v_pk_add_f32 v[96:97], v[96:97], v[14:15] neg_lo:[0,1] neg_hi:[0,1]
  v_cvt_pk_bf16_f32 v97, v96, v97
  v_lshlrev_b32 v96, 16, v97
  v_and_b32 v97, s86, v97
  v_pk_mul_f32 v[98:99], v[96:97], v[12:13]
  v_pk_fma_f32 v[100:101], v[98:99], v[10:11], v[96:97] neg_lo:[1,0,0] neg_hi:[1,0,0]
  v_pk_fma_f32 v[98:99], v[100:101], v[12:13], v[98:99]
  v_cvt_pk_bf16_f32 v59, v98, v99
  s_waitcnt lgkmcnt(0)
  v_mfma_f32_16x16x32_bf16 v[104:107], v[128:131], v[44:47], 0
  v_mfma_f32_16x16x32_bf16 v[108:111], v[132:135], v[44:47], 0
  v_mfma_f32_16x16x32_bf16 v[112:115], v[136:139], v[44:47], 0
  v_mfma_f32_16x16x32_bf16 v[116:119], v[140:143], v[44:47], 0
  v_mfma_f32_16x16x32_bf16 v[104:107], v[144:147], v[48:51], v[104:107]
  v_mfma_f32_16x16x32_bf16 v[108:111], v[148:151], v[48:51], v[108:111]
  v_mfma_f32_16x16x32_bf16 v[112:115], v[152:155], v[48:51], v[112:115]
  v_mfma_f32_16x16x32_bf16 v[116:119], v[156:159], v[48:51], v[116:119]
  v_mfma_f32_16x16x32_bf16 v[104:107], v[160:163], v[52:55], v[104:107]
  v_mfma_f32_16x16x32_bf16 v[108:111], v[164:167], v[52:55], v[108:111]
  v_mfma_f32_16x16x32_bf16 v[112:115], v[168:171], v[52:55], v[112:115]
  v_mfma_f32_16x16x32_bf16 v[116:119], v[172:175], v[52:55], v[116:119]
  v_mfma_f32_16x16x32_bf16 v[104:107], v[176:179], v[56:59], v[104:107]
  v_mfma_f32_16x16x32_bf16 v[108:111], v[180:183], v[56:59], v[108:111]
  v_mfma_f32_16x16x32_bf16 v[112:115], v[184:187], v[56:59], v[112:115]
  v_mfma_f32_16x16x32_bf16 v[116:119], v[188:191], v[56:59], v[116:119]
  v_lshlrev_b32 v14, 7, v3
  v_lshl_add_u32 v14, v2, 4, v14
  s_mov_b32 s84, 0x00ff00ff
  s_mov_b32 s85, 0x00ff00ff
  s_lshl_b32 s80, s3, 11
  s_add_u32 s80, s80, 143360
  v_add_u32 v15, s80, v14
  s_lshl_b32 s80, s3, 9
  s_add_u32 s80, s80, 143360
  v_add_u32 v14, s80, v14
  s_mov_b64 exec, s[84:85]
  ds_write_b128 v15, v[104:107] offset:0
  ds_write_b128 v15, v[108:111] offset:512
  ds_write_b128 v15, v[112:115] offset:1024
  ds_write_b128 v15, v[116:119] offset:1536
  s_mov_b64 exec, -1
  s_waitcnt lgkmcnt(0)
  v_mov_b32 v10, 162816
  v_mov_b32 v11, 1
  s_mov_b64 exec, 1
  ds_add_u32 v10, v11 offset:0
  s_mov_b64 exec, -1
  s_lshl_b32 s80, s3, 8
  s_add_u32 s80, s80, 159744
  v_lshlrev_b32 v40, 5, v2
  v_lshl_add_u32 v40, v3, 3, v40
  v_add_u32 v40, s80, v40
  v_lshlrev_b32 v12, 4, v2
  v_add_u32 v12, s80, v12
  v_bfe_u32 v13, v1, 1, 3
  v_lshlrev_b32 v13, 13, v13
  v_lshl_add_u32 v13, v3, 16, v13
  v_and_b32 v15, 1, v1
  v_lshl_add_u32 v13, v15, 4, v13
  s_lshl_b32 s80, s30, 10
  s_lshl_b32 s81, s41, 7
  s_add_u32 s80, s80, s81
  s_lshl_b32 s81, s3, 5
  s_add_u32 s80, s80, s81
  v_mov_b32 v10, 162816
L_wfc:
  ds_read_b32 v11, v10 offset:0
  s_waitcnt lgkmcnt(0)
  v_cmp_gt_u32 vcc, 4, v11
  s_cbranch_vccz L_wfc_ok
  s_sub_u32 s88, s88, 1
  s_cmp_eq_u32 s88, 0
  s_cbranch_scc1 L_end
  s_branch L_wfc
L_wfc_ok:
  ds_read_b128 v[16:19], v14 offset:0
  ds_read_b128 v[20:23], v14 offset:2048
  ds_read_b128 v[24:27], v14 offset:4096
  ds_read_b128 v[28:31], v14 offset:6144
  s_waitcnt lgkmcnt(0)
  v_pk_add_f32 v[16:17], v[16:17], v[20:21]
  v_pk_add_f32 v[18:19], v[18:19], v[22:23]
  v_pk_add_f32 v[24:25], v[24:25], v[28:29]
  v_pk_add_f32 v[26:27], v[26:27], v[30:31]
  v_pk_add_f32 v[16:17], v[16:17], v[24:25]
  v_pk_add_f32 v[18:19], v[18:19], v[26:27]
  v_cvt_pk_bf16_f32 v16, v16, v17
  v_cvt_pk_bf16_f32 v17, v18, v19
  s_mov_b64 exec, s[84:85]
  ds_write_b64 v40, v[16:17]
  s_mov_b64 exec, -1
  s_waitcnt lgkmcnt(0)
  ds_read_b128 v[20:23], v12
  s_waitcnt lgkmcnt(0)
  buffer_store_dwordx4 v[20:23], v13, s[16:19], s80 offen sc1
  s_setprio 0
  s_waitcnt vmcnt(0)
  v_mov_b32 v10, 162816
  v_mov_b32 v11, 1
  s_mov_b64 exec, 1
  ds_add_u32 v10, v11 offset:4
  s_mov_b64 exec, -1
  s_cmp_eq_u32 s3, 0
  s_cbranch_scc0 L_pf
  s_mov_b32 s40, 0
L_arrive:
  v_mov_b32 v10, 162816
L_wfd:
  ds_read_b32 v11, v10 offset:4
  s_waitcnt lgkmcnt(0)
  v_cmp_gt_u32 vcc, 4, v11
  s_cbranch_vccz L_wfd_ok
  s_sub_u32 s88, s88, 1
  s_cmp_eq_u32 s88, 0
  s_cbranch_scc1 L_end
  s_branch L_wfd
L_wfd_ok:
  s_lshl_b32 s80, s30, 5
  s_add_u32 s82, s56, s80
  s_addc_u32 s83, s57, 0
  s_mov_b32 s80, 1
  s_atomic_add s80, s[82:83], 0 glc
  s_lshl_b32 s81, s30, 13
  s_add_u32 s81, s81, 0x100880
  s_add_u32 s82, s58, s81
  s_addc_u32 s83, s59, 0
  s_waitcnt lgkmcnt(0)
  s_and_b32 s80, s80, 31
  s_cmp_eq_u32 s80, 31
  s_cbranch_scc0 L_nonot
  s_mov_b32 s80, 1
  s_atomic_add s80, s[82:83], 0x0
  s_atomic_add s80, s[82:83], 0x10000
  s_atomic_add s80, s[82:83], 0x20000
  s_atomic_add s80, s[82:83], 0x30000
  s_atomic_add s80, s[82:83], 0x40000
  s_atomic_add s80, s[82:83], 0x50000
  s_atomic_add s80, s[82:83], 0x60000
  s_atomic_add s80, s[82:83], 0x70000
  s_atomic_add s80, s[82:83], 0x80000
  s_atomic_add s80, s[82:83], 0x90000
  s_atomic_add s80, s[82:83], 0xa0000
  s_atomic_add s80, s[82:83], 0xb0000
  s_atomic_add s80, s[82:83], 0xc0000
  s_atomic_add s80, s[82:83], 0xd0000
  s_atomic_add s80, s[82:83], 0xe0000
  s_atomic_add s80, s[82:83], 0xf0000
  s_add_u32 s82, s82, 0x100000
  s_addc_u32 s83, s83, 0
  s_atomic_add s80, s[82:83], 0x0
  s_atomic_add s80, s[82:83], 0x10000
  s_atomic_add s80, s[82:83], 0x20000
  s_atomic_add s80, s[82:83], 0x30000
  s_atomic_add s80, s[82:83], 0x40000
  s_atomic_add s80, s[82:83], 0x50000
  s_atomic_add s80, s[82:83], 0x60000
  s_atomic_add s80, s[82:83], 0x70000
  s_atomic_add s80, s[82:83], 0x80000
  s_atomic_add s80, s[82:83], 0x90000
  s_atomic_add s80, s[82:83], 0xa0000
  s_atomic_add s80, s[82:83], 0xb0000
  s_atomic_add s80, s[82:83], 0xc0000
  s_atomic_add s80, s[82:83], 0xd0000
  s_atomic_add s80, s[82:83], 0xe0000
  s_atomic_add s80, s[82:83], 0xf0000
L_nonot:
  s_cmp_eq_u32 s40, 1
  s_cbranch_scc1 L_pf2
L_pf:
  buffer_load_dwordx4 v[128:131], v4, s[8:11], s28 offen offset:0 nt
  buffer_load_dwordx4 v[132:135], v4, s[8:11], s28 offen offset:64 nt
  buffer_load_dwordx4 v[136:139], v4, s[8:11], s28 offen offset:128 nt
  buffer_load_dwordx4 v[140:143], v4, s[8:11], s28 offen offset:192 nt
  buffer_load_dwordx4 v[144:147], v4, s[8:11], s28 offen offset:256 nt
  buffer_load_dwordx4 v[148:151], v4, s[8:11], s28 offen offset:320 nt
  buffer_load_dwordx4 v[152:155], v4, s[8:11], s28 offen offset:384 nt
  buffer_load_dwordx4 v[156:159], v4, s[8:11], s28 offen offset:448 nt
L_pf2:
  buffer_load_dwordx4 v[160:163], v5, s[8:11], s28 offen offset:0 nt
  buffer_load_dwordx4 v[164:167], v5, s[8:11], s28 offen offset:64 nt
  buffer_load_dwordx4 v[168:171], v5, s[8:11], s28 offen offset:128 nt
  buffer_load_dwordx4 v[172:175], v5, s[8:11], s28 offen offset:192 nt
  buffer_load_dwordx4 v[176:179], v5, s[8:11], s28 offen offset:256 nt
  buffer_load_dwordx4 v[180:183], v5, s[8:11], s28 offen offset:320 nt
  buffer_load_dwordx4 v[184:187], v5, s[8:11], s28 offen offset:384 nt
  buffer_load_dwordx4 v[188:191], v5, s[8:11], s28 offen offset:448 nt
  buffer_load_dwordx4 v[192:195], v6, s[12:15], s28 offen offset:0 nt
  buffer_load_dwordx4 v[196:199], v6, s[12:15], s28 offen offset:512 nt
  buffer_load_dwordx4 v[200:203], v6, s[12:15], s28 offen offset:1024 nt
  buffer_load_dwordx4 v[204:207], v6, s[12:15], s28 offen offset:1536 nt
  buffer_load_dwordx4 v[208:211], v7, s[12:15], s28 offen offset:0 nt
  buffer_load_dwordx4 v[212:215], v7, s[12:15], s28 offen offset:512 nt
  buffer_load_dwordx4 v[216:219], v7, s[12:15], s28 offen offset:1024 nt
  buffer_load_dwordx4 v[220:223], v7, s[12:15], s28 offen offset:1536 nt
  buffer_load_dwordx4 v[224:227], v6, s[12:15], s28 offen offset:256 nt
  buffer_load_dwordx4 v[228:231], v6, s[12:15], s28 offen offset:768 nt
  buffer_load_dwordx4 v[232:235], v6, s[12:15], s28 offen offset:1280 nt
  buffer_load_dwordx4 v[236:239], v6, s[12:15], s28 offen offset:1792 nt
  buffer_load_dwordx4 v[240:243], v7, s[12:15], s28 offen offset:256 nt
  buffer_load_dwordx4 v[244:247], v7, s[12:15], s28 offen offset:768 nt
  buffer_load_dwordx4 v[248:251], v7, s[12:15], s28 offen offset:1280 nt
  buffer_load_dwordx4 v[252:255], v7, s[12:15], s28 offen offset:1792 nt
  s_add_u32 s80, s28, 131072
  s_lshl_b32 s81, s3, 15
  s_mov_b32 m0, s81
  s_add_u32 s81, s81, 960
  buffer_load_dwordx4 v4, s[8:11], s80 offen offset:0 nt lds
  s_mov_b32 m0, s81
  s_add_u32 s81, s81, 960
  buffer_load_dwordx4 v4, s[8:11], s80 offen offset:64 nt lds
  s_mov_b32 m0, s81
  s_add_u32 s81, s81, 960
  buffer_load_dwordx4 v4, s[8:11], s80 offen offset:128 nt lds
  s_mov_b32 m0, s81
  s_add_u32 s81, s81, 960
  buffer_load_dwordx4 v4, s[8:11], s80 offen offset:192 nt lds
  s_mov_b32 m0, s81
  s_add_u32 s81, s81, 960
  buffer_load_dwordx4 v4, s[8:11], s80 offen offset:256 nt lds
  s_mov_b32 m0, s81
  s_add_u32 s81, s81, 960
  buffer_load_dwordx4 v4, s[8:11], s80 offen offset:320 nt lds
  s_mov_b32 m0, s81
  s_add_u32 s81, s81, 960
  buffer_load_dwordx4 v4, s[8:11], s80 offen offset:384 nt lds
  s_mov_b32 m0, s81
  s_add_u32 s81, s81, 1472
  buffer_load_dwordx4 v4, s[8:11], s80 offen offset:448 nt lds
  s_mov_b32 m0, s81
  s_add_u32 s81, s81, 960
  buffer_load_dwordx4 v5, s[8:11], s80 offen offset:0 nt lds
  s_mov_b32 m0, s81
  s_add_u32 s81, s81, 960
  buffer_load_dwordx4 v5, s[8:11], s80 offen offset:64 nt lds
  s_mov_b32 m0, s81
  s_add_u32 s81, s81, 960
  buffer_load_dwordx4 v5, s[8:11], s80 offen offset:128 nt lds
  s_mov_b32 m0, s81
  s_add_u32 s81, s81, 960
  buffer_load_dwordx4 v5, s[8:11], s80 offen offset:192 nt lds
  s_mov_b32 m0, s81
  s_add_u32 s81, s81, 960
  buffer_load_dwordx4 v5, s[8:11], s80 offen offset:256 nt lds
  s_mov_b32 m0, s81
  s_add_u32 s81, s81, 960
  buffer_load_dwordx4 v5, s[8:11], s80 offen offset:320 nt lds
  s_mov_b32 m0, s81
  s_add_u32 s81, s81, 960
  buffer_load_dwordx4 v5, s[8:11], s80 offen offset:384 nt lds
  s_mov_b32 m0, s81
  s_add_u32 s81, s81, 1472
  buffer_load_dwordx4 v5, s[8:11], s80 offen offset:448 nt lds
  s_mov_b32 m0, s81
  s_add_u32 s81, s81, 0x200
  buffer_load_dwordx4 v6, s[12:15], s80 offen offset:0 nt lds
  s_mov_b32 m0, s81
  s_add_u32 s81, s81, 0x200
  buffer_load_dwordx4 v6, s[12:15], s80 offen offset:512 nt lds
  s_mov_b32 m0, s81
  s_add_u32 s81, s81, 0x200
  buffer_load_dwordx4 v6, s[12:15], s80 offen offset:1024 nt lds
  s_mov_b32 m0, s81
  s_add_u32 s81, s81, 0xa00
  buffer_load_dwordx4 v6, s[12:15], s80 offen offset:1536 nt lds
  s_mov_b32 m0, s81
  s_add_u32 s81, s81, 0x200
  buffer_load_dwordx4 v7, s[12:15], s80 offen offset:0 nt lds
  s_mov_b32 m0, s81
  s_add_u32 s81, s81, 0x200
  buffer_load_dwordx4 v7, s[12:15], s80 offen offset:512 nt lds
  s_mov_b32 m0, s81
  s_add_u32 s81, s81, 0x200
  buffer_load_dwordx4 v7, s[12:15], s80 offen offset:1024 nt lds
  s_mov_b32 m0, s81
  s_add_u32 s81, s81, 0x900
  buffer_load_dwordx4 v7, s[12:15], s80 offen offset:1536 nt lds
  s_mov_b32 m0, s81
  s_add_u32 s81, s81, 0x200
  buffer_load_dwordx4 v6, s[12:15], s80 offen offset:256 nt lds
  s_mov_b32 m0, s81
  s_add_u32 s81, s81, 0x200
  buffer_load_dwordx4 v6, s[12:15], s80 offen offset:768 nt lds
  s_mov_b32 m0, s81
  s_add_u32 s81, s81, 0x200
  buffer_load_dwordx4 v6, s[12:15], s80 offen offset:1280 nt lds
  s_mov_b32 m0, s81
  s_add_u32 s81, s81, 0xa00
  buffer_load_dwordx4 v6, s[12:15], s80 offen offset:1792 nt lds
  s_mov_b32 m0, s81
  s_add_u32 s81, s81, 0x200
  buffer_load_dwordx4 v7, s[12:15], s80 offen offset:256 nt lds
  s_mov_b32 m0, s81
  s_add_u32 s81, s81, 0x200
  buffer_load_dwordx4 v7, s[12:15], s80 offen offset:768 nt lds
  s_mov_b32 m0, s81
  s_add_u32 s81, s81, 0x200
  buffer_load_dwordx4 v7, s[12:15], s80 offen offset:1280 nt lds
  s_mov_b32 m0, s81
  s_add_u32 s81, s81, 0xb00
  buffer_load_dwordx4 v7, s[12:15], s80 offen offset:1792 nt lds
L_qwait:
  s_mov_b32 s64, 0x30003
  s_mov_b32 s65, 0x30003
  s_mov_b32 s66, 0xc000c
  s_mov_b32 s67, 0xc000c
  s_mov_b32 s68, 0x300030
  s_mov_b32 s69, 0x300030
  s_mov_b32 s70, 0xc000c0
  s_mov_b32 s71, 0xc000c0
  s_mov_b32 s72, 0x3000300
  s_mov_b32 s73, 0x3000300
  s_mov_b32 s74, 0xc000c00
  s_mov_b32 s75, 0xc000c00
  s_mov_b32 s76, 0x30003000
  s_mov_b32 s77, 0x30003000
  s_mov_b32 s78, 0xc000c000
  s_mov_b32 s79, 0xc000c000
  v_lshrrev_b32 v12, 7, v0
  s_lshl_b32 s80, s31, 5
  s_add_u32 s80, s80, s30
  v_lshlrev_b32 v12, 3, v12
  v_add_u32 v12, s80, v12
  v_lshlrev_b32 v8, 13, v12
  v_and_b32 v13, 127, v0
  v_lshl_add_u32 v8, v13, 2, v8
  s_lshl_b32 s80, s32, 9
  s_add_u32 s80, s80, 0x100000
  v_add_u32 v8, s80, v8
  v_lshlrev_b32 v12, 3, v3
  v_add_u32 v12, s3, v12
  v_lshl_add_u32 v12, v12, 4, v2
  v_mul_u32_u24 v13, 4682, v12
  v_lshrrev_b32 v13, 16, v13
  v_mul_u32_u24 v14, 14, v13
  v_sub_u32 v14, v12, v14
  v_and_b32 v15, 3, v13
  v_lshlrev_b32 v15, 3, v15
  v_lshrrev_b32 v13, 2, v13
  v_add_u32 v15, v15, v13
  s_lshl_b32 s80, s31, 5
  v_add_u32 v15, s80, v15
  v_lshlrev_b32 v9, 13, v15
  v_lshl_add_u32 v9, v14, 2, v9
  s_lshl_b32 s80, s87, 6
  s_add_u32 s80, s80, 0x100900
  v_add_u32 v9, s80, v9
  v_cmp_lt_u32 vcc, 447, v12
  v_mov_b32 v13, 0x7ffffff0
  s_nop 0
  v_cndmask_b32 v9, v9, v13, vcc
  v_mov_b32 v48, 0
  v_mov_b32 v49, 0
  v_mov_b32 v50, 0
  v_mov_b32 v51, 0
  v_mov_b32 v52, 0
  v_mov_b32 v53, 0
  v_mov_b32 v54, 0
  v_mov_b32 v55, 0
  v_mov_b32 v76, 0xf149f2ca
  v_mov_b32 v77, 0
  v_and_b32 v14, 1, v2
  v_lshlrev_b32 v14, 9, v14
  v_lshl_add_u32 v14, v3, 4, v14
  v_add_u32 v14, 161792, v14
  s_nop 0
  v_mov_b32 v10, 162816
L_wfq:
  ds_read_b32 v11, v10 offset:12
  s_waitcnt lgkmcnt(0)
  v_cmp_gt_u32 vcc, 4, v11
  s_cbranch_vccz L_wfq_ok
  s_sub_u32 s88, s88, 1
  s_cmp_eq_u32 s88, 0
  s_cbranch_scc1 L_end
  s_branch L_wfq
L_wfq_ok:
  ds_read_b128 v[16:19], v14 offset:0
  ds_read_b128 v[20:23], v14 offset:64
  ds_read_b128 v[24:27], v14 offset:128
  ds_read_b128 v[28:31], v14 offset:192
  ds_read_b128 v[32:35], v14 offset:256
  ds_read_b128 v[36:39], v14 offset:320
  ds_read_b128 v[40:43], v14 offset:384
  ds_read_b128 v[44:47], v14 offset:448
  s_waitcnt lgkmcnt(0)
  s_cmp_ge_u32 s3, 4
  s_cbranch_scc1 L_last
  s_add_u32 s28, s28, 196608
  s_waitcnt vmcnt(56)
  v_mfma_f32_16x16x32_bf16 v[56:59], v[128:131], v[16:19], 0
  v_mfma_f32_16x16x32_bf16 v[56:59], v[132:135], v[20:23], v[56:59]
  v_mfma_f32_16x16x32_bf16 v[56:59], v[136:139], v[24:27], v[56:59]
  v_mfma_f32_16x16x32_bf16 v[56:59], v[140:143], v[28:31], v[56:59]
  v_mfma_f32_16x16x32_bf16 v[56:59], v[144:147], v[32:35], v[56:59]
  v_mfma_f32_16x16x32_bf16 v[56:59], v[148:151], v[36:39], v[56:59]
  v_mfma_f32_16x16x32_bf16 v[56:59], v[152:155], v[40:43], v[56:59]
  v_mfma_f32_16x16x32_bf16 v[56:59], v[156:159], v[44:47], v[56:59]
  buffer_load_dwordx4 v[128:131], v4, s[8:11], s28 offen offset:0 nt
  buffer_load_dwordx4 v[132:135], v4, s[8:11], s28 offen offset:64 nt
  buffer_load_dwordx4 v[136:139], v4, s[8:11], s28 offen offset:128 nt
  buffer_load_dwordx4 v[140:143], v4, s[8:11], s28 offen offset:192 nt
  buffer_load_dwordx4 v[144:147], v4, s[8:11], s28 offen offset:256 nt
  buffer_load_dwordx4 v[148:151], v4, s[8:11], s28 offen offset:320 nt
  buffer_load_dwordx4 v[152:155], v4, s[8:11], s28 offen offset:384 nt
  buffer_load_dwordx4 v[156:159], v4, s[8:11], s28 offen offset:448 nt
  s_waitcnt vmcnt(56)
  v_mfma_f32_16x16x32_bf16 v[60:63], v[160:163], v[16:19], 0
  v_mfma_f32_16x16x32_bf16 v[60:63], v[164:167], v[20:23], v[60:63]
  v_mfma_f32_16x16x32_bf16 v[60:63], v[168:171], v[24:27], v[60:63]
  v_mfma_f32_16x16x32_bf16 v[60:63], v[172:175], v[28:31], v[60:63]
  v_mfma_f32_16x16x32_bf16 v[60:63], v[176:179], v[32:35], v[60:63]
  v_mfma_f32_16x16x32_bf16 v[60:63], v[180:183], v[36:39], v[60:63]
  v_mfma_f32_16x16x32_bf16 v[60:63], v[184:187], v[40:43], v[60:63]
  v_mfma_f32_16x16x32_bf16 v[60:63], v[188:191], v[44:47], v[60:63]
  buffer_load_dwordx4 v[160:163], v5, s[8:11], s28 offen offset:0 nt
  buffer_load_dwordx4 v[164:167], v5, s[8:11], s28 offen offset:64 nt
  buffer_load_dwordx4 v[168:171], v5, s[8:11], s28 offen offset:128 nt
  buffer_load_dwordx4 v[172:175], v5, s[8:11], s28 offen offset:192 nt
  buffer_load_dwordx4 v[176:179], v5, s[8:11], s28 offen offset:256 nt
  buffer_load_dwordx4 v[180:183], v5, s[8:11], s28 offen offset:320 nt
  buffer_load_dwordx4 v[184:187], v5, s[8:11], s28 offen offset:384 nt
  buffer_load_dwordx4 v[188:191], v5, s[8:11], s28 offen offset:448 nt
  v_cvt_pk_bf16_f32 v64, v56, v57
  v_cvt_pk_bf16_f32 v65, v58, v59
  v_cvt_pk_bf16_f32 v66, v60, v61
  v_cvt_pk_bf16_f32 v67, v62, v63
  v_lshlrev_b32 v56, 16, v64
  v_and_b32 v57, s86, v64
  v_lshlrev_b32 v58, 16, v65
  v_and_b32 v59, s86, v65
  v_lshlrev_b32 v60, 16, v66
  v_and_b32 v61, s86, v66
  v_lshlrev_b32 v62, 16, v67
  v_and_b32 v63, s86, v67
  v_max3_f32 v10, v56, v57, v58
  v_max3_f32 v11, v59, v60, v61
  v_max3_f32 v10, v10, v62, v63
  v_max_f32 v10, v10, v11
  v_mov_b32 v11, v10
  s_nop 1
  v_permlane16_swap_b32 v10, v11
  s_nop 0
  v_max_f32 v10, v10, v11
  v_mov_b32 v11, v10
  s_nop 1
  v_permlane32_swap_b32 v10, v11
  s_nop 0
  v_max_f32 v10, v10, v11
  v_max_f32 v10, v10, v76
  v_sub_f32 v78, v76, v10
  v_mul_f32 v78, s34, v78
  v_exp_f32 v78, v78
  v_mov_b32 v76, v10
  v_mul_f32 v79, s34, v10
  v_fma_f32 v56, v56, s34, -v79
  v_fma_f32 v57, v57, s34, -v79
  v_fma_f32 v58, v58, s34, -v79
  v_fma_f32 v59, v59, s34, -v79
  v_fma_f32 v60, v60, s34, -v79
  v_fma_f32 v61, v61, s34, -v79
  v_fma_f32 v62, v62, s34, -v79
  v_fma_f32 v63, v63, s34, -v79
  v_exp_f32 v56, v56
  v_exp_f32 v57, v57
  v_exp_f32 v58, v58
  v_exp_f32 v59, v59
  v_exp_f32 v60, v60
  v_exp_f32 v61, v61
  v_exp_f32 v62, v62
  v_exp_f32 v63, v63
  v_mul_f32_dpp v48, v78, v48 quad_perm:[0,0,2,2] row_mask:0xf bank_mask:0xf
  v_mul_f32_dpp v49, v78, v49 quad_perm:[1,1,3,3] row_mask:0xf bank_mask:0xf
  v_mul_f32_dpp v50, v78, v50 quad_perm:[0,0,2,2] row_mask:0xf bank_mask:0xf
  v_mul_f32_dpp v51, v78, v51 quad_perm:[1,1,3,3] row_mask:0xf bank_mask:0xf
  v_mul_f32_dpp v52, v78, v52 quad_perm:[0,0,2,2] row_mask:0xf bank_mask:0xf
  v_mul_f32_dpp v53, v78, v53 quad_perm:[1,1,3,3] row_mask:0xf bank_mask:0xf
  v_mul_f32_dpp v54, v78, v54 quad_perm:[0,0,2,2] row_mask:0xf bank_mask:0xf
  v_mul_f32_dpp v55, v78, v55 quad_perm:[1,1,3,3] row_mask:0xf bank_mask:0xf
  v_cvt_pk_bf16_f32 v64, v56, v57
  v_cvt_pk_bf16_f32 v65, v58, v59
  v_cvt_pk_bf16_f32 v66, v60, v61
  v_cvt_pk_bf16_f32 v67, v62, v63
  v_add_f32 v10, v56, v57
  v_add_f32 v11, v58, v59
  v_add_f32 v12, v60, v61
  v_add_f32 v13, v62, v63
  v_add_f32 v10, v10, v11
  v_add_f32 v12, v12, v13
  v_add_f32 v10, v10, v12
  v_fma_f32 v77, v77, v78, v10
  v_cndmask_b32 v80, 0, v64, s[64:65]
  v_cndmask_b32 v81, 0, v65, s[64:65]
  v_cndmask_b32 v82, 0, v66, s[64:65]
  v_cndmask_b32 v83, 0, v67, s[64:65]
  v_cndmask_b32 v84, 0, v64, s[66:67]
  v_cndmask_b32 v85, 0, v65, s[66:67]
  v_cndmask_b32 v86, 0, v66, s[66:67]
  v_cndmask_b32 v87, 0, v67, s[66:67]
  v_cndmask_b32 v88, 0, v64, s[68:69]
  v_cndmask_b32 v89, 0, v65, s[68:69]
  v_cndmask_b32 v90, 0, v66, s[68:69]
  v_cndmask_b32 v91, 0, v67, s[68:69]
  v_cndmask_b32 v92, 0, v64, s[70:71]
  v_cndmask_b32 v93, 0, v65, s[70:71]
  v_cndmask_b32 v94, 0, v66, s[70:71]
  v_cndmask_b32 v95, 0, v67, s[70:71]
  v_cndmask_b32 v96, 0, v64, s[72:73]
  v_cndmask_b32 v97, 0, v65, s[72:73]
  v_cndmask_b32 v98, 0, v66, s[72:73]
  v_cndmask_b32 v99, 0, v67, s[72:73]
  v_cndmask_b32 v100, 0, v64, s[74:75]
  v_cndmask_b32 v101, 0, v65, s[74:75]
  v_cndmask_b32 v102, 0, v66, s[74:75]
  v_cndmask_b32 v103, 0, v67, s[74:75]
  v_cndmask_b32 v104, 0, v64, s[76:77]
  v_cndmask_b32 v105, 0, v65, s[76:77]
  v_cndmask_b32 v106, 0, v66, s[76:77]
  v_cndmask_b32 v107, 0, v67, s[76:77]
  v_cndmask_b32 v108, 0, v64, s[78:79]
  v_cndmask_b32 v109, 0, v65, s[78:79]
  v_cndmask_b32 v110, 0, v66, s[78:79]
  v_cndmask_b32 v111, 0, v67, s[78:79]
  s_waitcnt vmcnt(56)
  v_perm_b32 v112, v196, v192, s35
  v_perm_b32 v113, v204, v200, s35
  v_perm_b32 v114, v212, v208, s35
  v_perm_b32 v115, v220, v216, s35
  v_perm_b32 v116, v196, v192, s60
  v_perm_b32 v117, v204, v200, s60
  v_perm_b32 v118, v212, v208, s60
  v_perm_b32 v119, v220, v216, s60
  v_perm_b32 v120, v197, v193, s35
  v_perm_b32 v121, v205, v201, s35
  v_perm_b32 v122, v213, v209, s35
  v_perm_b32 v123, v221, v217, s35
  v_mfma_f32_16x16x32_bf16 v[48:51], v[80:83], v[112:115], v[48:51]
  v_perm_b32 v124, v197, v193, s60
  v_perm_b32 v125, v205, v201, s60
  v_perm_b32 v126, v213, v209, s60
  v_perm_b32 v127, v221, v217, s60
  v_mfma_f32_16x16x32_bf16 v[48:51], v[84:87], v[116:119], v[48:51]
  v_perm_b32 v112, v198, v194, s35
  v_perm_b32 v113, v206, v202, s35
  v_perm_b32 v114, v214, v210, s35
  v_perm_b32 v115, v222, v218, s35
  v_mfma_f32_16x16x32_bf16 v[48:51], v[88:91], v[120:123], v[48:51]
  v_perm_b32 v116, v198, v194, s60
  v_perm_b32 v117, v206, v202, s60
  v_perm_b32 v118, v214, v210, s60
  v_perm_b32 v119, v222, v218, s60
  v_mfma_f32_16x16x32_bf16 v[48:51], v[92:95], v[124:127], v[48:51]
  v_perm_b32 v120, v199, v195, s35
  v_perm_b32 v121, v207, v203, s35
  v_perm_b32 v122, v215, v211, s35
  v_perm_b32 v123, v223, v219, s35
  v_mfma_f32_16x16x32_bf16 v[48:51], v[96:99], v[112:115], v[48:51]
  v_perm_b32 v124, v199, v195, s60
  v_perm_b32 v125, v207, v203, s60
  v_perm_b32 v126, v215, v211, s60
  v_perm_b32 v127, v223, v219, s60
  v_mfma_f32_16x16x32_bf16 v[48:51], v[100:103], v[116:119], v[48:51]
  s_nop 0
  v_mfma_f32_16x16x32_bf16 v[48:51], v[104:107], v[120:123], v[48:51]
  s_nop 0
  v_mfma_f32_16x16x32_bf16 v[48:51], v[108:111], v[124:127], v[48:51]
  buffer_load_dwordx4 v[192:195], v6, s[12:15], s28 offen offset:0 nt
  buffer_load_dwordx4 v[196:199], v6, s[12:15], s28 offen offset:512 nt
  buffer_load_dwordx4 v[200:203], v6, s[12:15], s28 offen offset:1024 nt
  buffer_load_dwordx4 v[204:207], v6, s[12:15], s28 offen offset:1536 nt
  buffer_load_dwordx4 v[208:211], v7, s[12:15], s28 offen offset:0 nt
  buffer_load_dwordx4 v[212:215], v7, s[12:15], s28 offen offset:512 nt
  buffer_load_dwordx4 v[216:219], v7, s[12:15], s28 offen offset:1024 nt
  buffer_load_dwordx4 v[220:223], v7, s[12:15], s28 offen offset:1536 nt
  s_waitcnt vmcnt(56)
  v_perm_b32 v112, v228, v224, s35
  v_perm_b32 v113, v236, v232, s35
  v_perm_b32 v114, v244, v240, s35
  v_perm_b32 v115, v252, v248, s35
  v_perm_b32 v116, v228, v224, s60
  v_perm_b32 v117, v236, v232, s60
  v_perm_b32 v118, v244, v240, s60
  v_perm_b32 v119, v252, v248, s60
  v_perm_b32 v120, v229, v225, s35
  v_perm_b32 v121, v237, v233, s35
  v_perm_b32 v122, v245, v241, s35
  v_perm_b32 v123, v253, v249, s35
  v_mfma_f32_16x16x32_bf16 v[52:55], v[80:83], v[112:115], v[52:55]
  v_perm_b32 v124, v229, v225, s60
  v_perm_b32 v125, v237, v233, s60
  v_perm_b32 v126, v245, v241, s60
  v_perm_b32 v127, v253, v249, s60
  v_mfma_f32_16x16x32_bf16 v[52:55], v[84:87], v[116:119], v[52:55]
  v_perm_b32 v112, v230, v226, s35
  v_perm_b32 v113, v238, v234, s35
  v_perm_b32 v114, v246, v242, s35
  v_perm_b32 v115, v254, v250, s35
  v_mfma_f32_16x16x32_bf16 v[52:55], v[88:91], v[120:123], v[52:55]
  v_perm_b32 v116, v230, v226, s60
  v_perm_b32 v117, v238, v234, s60
  v_perm_b32 v118, v246, v242, s60
  v_perm_b32 v119, v254, v250, s60
  v_mfma_f32_16x16x32_bf16 v[52:55], v[92:95], v[124:127], v[52:55]
  v_perm_b32 v120, v231, v227, s35
  v_perm_b32 v121, v239, v235, s35
  v_perm_b32 v122, v247, v243, s35
  v_perm_b32 v123, v255, v251, s35
  v_mfma_f32_16x16x32_bf16 v[52:55], v[96:99], v[112:115], v[52:55]
  v_perm_b32 v124, v231, v227, s60
  v_perm_b32 v125, v239, v235, s60
  v_perm_b32 v126, v247, v243, s60
  v_perm_b32 v127, v255, v251, s60
  v_mfma_f32_16x16x32_bf16 v[52:55], v[100:103], v[116:119], v[52:55]
  s_nop 0
  v_mfma_f32_16x16x32_bf16 v[52:55], v[104:107], v[120:123], v[52:55]
  s_nop 0
  v_mfma_f32_16x16x32_bf16 v[52:55], v[108:111], v[124:127], v[52:55]
  buffer_load_dwordx4 v[224:227], v6, s[12:15], s28 offen offset:256 nt
  buffer_load_dwordx4 v[228:231], v6, s[12:15], s28 offen offset:768 nt
  buffer_load_dwordx4 v[232:235], v6, s[12:15], s28 offen offset:1280 nt
  buffer_load_dwordx4 v[236:239], v6, s[12:15], s28 offen offset:1792 nt
  buffer_load_dwordx4 v[240:243], v7, s[12:15], s28 offen offset:256 nt
  buffer_load_dwordx4 v[244:247], v7, s[12:15], s28 offen offset:768 nt
  buffer_load_dwordx4 v[248:251], v7, s[12:15], s28 offen offset:1280 nt
  buffer_load_dwordx4 v[252:255], v7, s[12:15], s28 offen offset:1792 nt
  s_add_u32 s28, s28, 65536
  s_mov_b32 s40, 12
  s_mov_b32 s41, 0
  s_lshl_b32 s80, s3, 2
  s_add_u32 s80, s80, 162832
  v_mov_b32 v10, s80
  v_mov_b32 v11, 1
  s_waitcnt vmcnt(32)
  s_mov_b64 exec, 1
  ds_write_b32 v10, v11
  s_mov_b64 exec, -1
  s_cmp_eq_u32 s31, 7
  s_cbranch_scc1 L_nobal
  s_cmp_lt_u32 s31, 4
  s_cselect_b32 s81, 12, 12
  s_cselect_b32 s82, 0, 0
  s_cmp_eq_u32 s82, 1
  s_cbranch_scc1 L_nobal
  s_lshl_b32 s80, s32, 2
  s_add_u32 s80, s80, s3
  s_cmp_eq_u32 s80, 3
  s_cselect_b32 s40, 11, s40
  s_cmp_eq_u32 s80, s81
  s_cselect_b32 s40, 13, s40
  s_cselect_b32 s41, 1, 0
L_nobal:
L_loop:
  s_cmp_eq_u32 s40, s41
  s_cbranch_scc0 L_nosp
  s_lshl_b32 s80, s32, 20
  s_sub_u32 s28, s29, s80
  s_add_u32 s28, s28, 1032192
L_nosp:
  s_waitcnt vmcnt(24)
  v_mfma_f32_16x16x32_bf16 v[56:59], v[128:131], v[16:19], 0
  v_mfma_f32_16x16x32_bf16 v[56:59], v[132:135], v[20:23], v[56:59]
  v_mfma_f32_16x16x32_bf16 v[56:59], v[136:139], v[24:27], v[56:59]
  v_mfma_f32_16x16x32_bf16 v[56:59], v[140:143], v[28:31], v[56:59]
  v_mfma_f32_16x16x32_bf16 v[56:59], v[144:147], v[32:35], v[56:59]
  v_mfma_f32_16x16x32_bf16 v[56:59], v[148:151], v[36:39], v[56:59]
  v_mfma_f32_16x16x32_bf16 v[56:59], v[152:155], v[40:43], v[56:59]
  v_mfma_f32_16x16x32_bf16 v[56:59], v[156:159], v[44:47], v[56:59]
  buffer_load_dwordx4 v[128:131], v4, s[8:11], s28 offen offset:0 nt
  buffer_load_dwordx4 v[132:135], v4, s[8:11], s28 offen offset:64 nt
  buffer_load_dwordx4 v[136:139], v4, s[8:11], s28 offen offset:128 nt
  buffer_load_dwordx4 v[140:143], v4, s[8:11], s28 offen offset:192 nt
  buffer_load_dwordx4 v[144:147], v4, s[8:11], s28 offen offset:256 nt
  buffer_load_dwordx4 v[148:151], v4, s[8:11], s28 offen offset:320 nt
  buffer_load_dwordx4 v[152:155], v4, s[8:11], s28 offen offset:384 nt
  buffer_load_dwordx4 v[156:159], v4, s[8:11], s28 offen offset:448 nt
  s_waitcnt vmcnt(24)
  v_mfma_f32_16x16x32_bf16 v[60:63], v[160:163], v[16:19], 0
  v_mfma_f32_16x16x32_bf16 v[60:63], v[164:167], v[20:23], v[60:63]
  v_mfma_f32_16x16x32_bf16 v[60:63], v[168:171], v[24:27], v[60:63]
  v_mfma_f32_16x16x32_bf16 v[60:63], v[172:175], v[28:31], v[60:63]
  v_mfma_f32_16x16x32_bf16 v[60:63], v[176:179], v[32:35], v[60:63]
  v_mfma_f32_16x16x32_bf16 v[60:63], v[180:183], v[36:39], v[60:63]
  v_mfma_f32_16x16x32_bf16 v[60:63], v[184:187], v[40:43], v[60:63]
  v_mfma_f32_16x16x32_bf16 v[60:63], v[188:191], v[44:47], v[60:63]
  buffer_load_dwordx4 v[160:163], v5, s[8:11], s28 offen offset:0 nt
  buffer_load_dwordx4 v[164:167], v5, s[8:11], s28 offen offset:64 nt
  buffer_load_dwordx4 v[168:171], v5, s[8:11], s28 offen offset:128 nt
  buffer_load_dwordx4 v[172:175], v5, s[8:11], s28 offen offset:192 nt
  buffer_load_dwordx4 v[176:179], v5, s[8:11], s28 offen offset:256 nt
  buffer_load_dwordx4 v[180:183], v5, s[8:11], s28 offen offset:320 nt
  buffer_load_dwordx4 v[184:187], v5, s[8:11], s28 offen offset:384 nt
  buffer_load_dwordx4 v[188:191], v5, s[8:11], s28 offen offset:448 nt
  v_cvt_pk_bf16_f32 v64, v56, v57
  v_cvt_pk_bf16_f32 v65, v58, v59
  v_cvt_pk_bf16_f32 v66, v60, v61
  v_cvt_pk_bf16_f32 v67, v62, v63
  v_lshlrev_b32 v56, 16, v64
  v_and_b32 v57, s86, v64
  v_lshlrev_b32 v58, 16, v65
  v_and_b32 v59, s86, v65
  v_lshlrev_b32 v60, 16, v66
  v_and_b32 v61, s86, v66
  v_lshlrev_b32 v62, 16, v67
  v_and_b32 v63, s86, v67
  v_max3_f32 v10, v56, v57, v58
  v_max3_f32 v11, v59, v60, v61
  v_max3_f32 v10, v10, v62, v63
  v_max_f32 v10, v10, v11
  v_mov_b32 v11, v10
  s_nop 1
  v_permlane16_swap_b32 v10, v11
  s_nop 0
  v_max_f32 v10, v10, v11
  v_mov_b32 v11, v10
  s_nop 1
  v_permlane32_swap_b32 v10, v11
  s_nop 0
  v_max_f32 v10, v10, v11
  v_max_f32 v10, v10, v76
  v_sub_f32 v78, v76, v10
  v_mul_f32 v78, s34, v78
  v_exp_f32 v78, v78
  v_mov_b32 v76, v10
  v_mul_f32 v79, s34, v10
  v_fma_f32 v56, v56, s34, -v79
  v_fma_f32 v57, v57, s34, -v79
  v_fma_f32 v58, v58, s34, -v79
  v_fma_f32 v59, v59, s34, -v79
  v_fma_f32 v60, v60, s34, -v79
  v_fma_f32 v61, v61, s34, -v79
  v_fma_f32 v62, v62, s34, -v79
  v_fma_f32 v63, v63, s34, -v79
  v_exp_f32 v56, v56
  v_exp_f32 v57, v57
  v_exp_f32 v58, v58
  v_exp_f32 v59, v59
  v_exp_f32 v60, v60
  v_exp_f32 v61, v61
  v_exp_f32 v62, v62
  v_exp_f32 v63, v63
  v_mul_f32_dpp v48, v78, v48 quad_perm:[0,0,2,2] row_mask:0xf bank_mask:0xf
  v_mul_f32_dpp v49, v78, v49 quad_perm:[1,1,3,3] row_mask:0xf bank_mask:0xf
  v_mul_f32_dpp v50, v78, v50 quad_perm:[0,0,2,2] row_mask:0xf bank_mask:0xf
  v_mul_f32_dpp v51, v78, v51 quad_perm:[1,1,3,3] row_mask:0xf bank_mask:0xf
  v_mul_f32_dpp v52, v78, v52 quad_perm:[0,0,2,2] row_mask:0xf bank_mask:0xf
  v_mul_f32_dpp v53, v78, v53 quad_perm:[1,1,3,3] row_mask:0xf bank_mask:0xf
  v_mul_f32_dpp v54, v78, v54 quad_perm:[0,0,2,2] row_mask:0xf bank_mask:0xf
  v_mul_f32_dpp v55, v78, v55 quad_perm:[1,1,3,3] row_mask:0xf bank_mask:0xf
  v_cvt_pk_bf16_f32 v64, v56, v57
  v_cvt_pk_bf16_f32 v65, v58, v59
  v_cvt_pk_bf16_f32 v66, v60, v61
  v_cvt_pk_bf16_f32 v67, v62, v63
  v_add_f32 v10, v56, v57
  v_add_f32 v11, v58, v59
  v_add_f32 v12, v60, v61
  v_add_f32 v13, v62, v63
  v_add_f32 v10, v10, v11
  v_add_f32 v12, v12, v13
  v_add_f32 v10, v10, v12
  v_fma_f32 v77, v77, v78, v10
  v_cndmask_b32 v80, 0, v64, s[64:65]
  v_cndmask_b32 v81, 0, v65, s[64:65]
  v_cndmask_b32 v82, 0, v66, s[64:65]
  v_cndmask_b32 v83, 0, v67, s[64:65]
  v_cndmask_b32 v84, 0, v64, s[66:67]
  v_cndmask_b32 v85, 0, v65, s[66:67]
  v_cndmask_b32 v86, 0, v66, s[66:67]
  v_cndmask_b32 v87, 0, v67, s[66:67]
  v_cndmask_b32 v88, 0, v64, s[68:69]
  v_cndmask_b32 v89, 0, v65, s[68:69]
  v_cndmask_b32 v90, 0, v66, s[68:69]
  v_cndmask_b32 v91, 0, v67, s[68:69]
  v_cndmask_b32 v92, 0, v64, s[70:71]
  v_cndmask_b32 v93, 0, v65, s[70:71]
  v_cndmask_b32 v94, 0, v66, s[70:71]
  v_cndmask_b32 v95, 0, v67, s[70:71]
  v_cndmask_b32 v96, 0, v64, s[72:73]
  v_cndmask_b32 v97, 0, v65, s[72:73]
  v_cndmask_b32 v98, 0, v66, s[72:73]
  v_cndmask_b32 v99, 0, v67, s[72:73]
  v_cndmask_b32 v100, 0, v64, s[74:75]
  v_cndmask_b32 v101, 0, v65, s[74:75]
  v_cndmask_b32 v102, 0, v66, s[74:75]
  v_cndmask_b32 v103, 0, v67, s[74:75]
  v_cndmask_b32 v104, 0, v64, s[76:77]
  v_cndmask_b32 v105, 0, v65, s[76:77]
  v_cndmask_b32 v106, 0, v66, s[76:77]
  v_cndmask_b32 v107, 0, v67, s[76:77]
  v_cndmask_b32 v108, 0, v64, s[78:79]
  v_cndmask_b32 v109, 0, v65, s[78:79]
  v_cndmask_b32 v110, 0, v66, s[78:79]
  v_cndmask_b32 v111, 0, v67, s[78:79]
  s_waitcnt vmcnt(24)
  v_perm_b32 v112, v196, v192, s35
  v_perm_b32 v113, v204, v200, s35
  v_perm_b32 v114, v212, v208, s35
  v_perm_b32 v115, v220, v216, s35
  v_perm_b32 v116, v196, v192, s60
  v_perm_b32 v117, v204, v200, s60
  v_perm_b32 v118, v212, v208, s60
  v_perm_b32 v119, v220, v216, s60
  v_perm_b32 v120, v197, v193, s35
  v_perm_b32 v121, v205, v201, s35
  v_perm_b32 v122, v213, v209, s35
  v_perm_b32 v123, v221, v217, s35
  v_mfma_f32_16x16x32_bf16 v[48:51], v[80:83], v[112:115], v[48:51]
  v_perm_b32 v124, v197, v193, s60
  v_perm_b32 v125, v205, v201, s60
  v_perm_b32 v126, v213, v209, s60
  v_perm_b32 v127, v221, v217, s60
  v_mfma_f32_16x16x32_bf16 v[48:51], v[84:87], v[116:119], v[48:51]
  v_perm_b32 v112, v198, v194, s35
  v_perm_b32 v113, v206, v202, s35
  v_perm_b32 v114, v214, v210, s35
  v_perm_b32 v115, v222, v218, s35
  v_mfma_f32_16x16x32_bf16 v[48:51], v[88:91], v[120:123], v[48:51]
  v_perm_b32 v116, v198, v194, s60
  v_perm_b32 v117, v206, v202, s60
  v_perm_b32 v118, v214, v210, s60
  v_perm_b32 v119, v222, v218, s60
  v_mfma_f32_16x16x32_bf16 v[48:51], v[92:95], v[124:127], v[48:51]
  v_perm_b32 v120, v199, v195, s35
  v_perm_b32 v121, v207, v203, s35
  v_perm_b32 v122, v215, v211, s35
  v_perm_b32 v123, v223, v219, s35
  v_mfma_f32_16x16x32_bf16 v[48:51], v[96:99], v[112:115], v[48:51]
  v_perm_b32 v124, v199, v195, s60
  v_perm_b32 v125, v207, v203, s60
  v_perm_b32 v126, v215, v211, s60
  v_perm_b32 v127, v223, v219, s60
  v_mfma_f32_16x16x32_bf16 v[48:51], v[100:103], v[116:119], v[48:51]
  s_nop 0
  v_mfma_f32_16x16x32_bf16 v[48:51], v[104:107], v[120:123], v[48:51]
  s_nop 0
  v_mfma_f32_16x16x32_bf16 v[48:51], v[108:111], v[124:127], v[48:51]
  buffer_load_dwordx4 v[192:195], v6, s[12:15], s28 offen offset:0 nt
  buffer_load_dwordx4 v[196:199], v6, s[12:15], s28 offen offset:512 nt
  buffer_load_dwordx4 v[200:203], v6, s[12:15], s28 offen offset:1024 nt
  buffer_load_dwordx4 v[204:207], v6, s[12:15], s28 offen offset:1536 nt
  buffer_load_dwordx4 v[208:211], v7, s[12:15], s28 offen offset:0 nt
  buffer_load_dwordx4 v[212:215], v7, s[12:15], s28 offen offset:512 nt
  buffer_load_dwordx4 v[216:219], v7, s[12:15], s28 offen offset:1024 nt
  buffer_load_dwordx4 v[220:223], v7, s[12:15], s28 offen offset:1536 nt
  s_waitcnt vmcnt(24)
  v_perm_b32 v112, v228, v224, s35
  v_perm_b32 v113, v236, v232, s35
  v_perm_b32 v114, v244, v240, s35
  v_perm_b32 v115, v252, v248, s35
  v_perm_b32 v116, v228, v224, s60
  v_perm_b32 v117, v236, v232, s60
  v_perm_b32 v118, v244, v240, s60
  v_perm_b32 v119, v252, v248, s60
  v_perm_b32 v120, v229, v225, s35
  v_perm_b32 v121, v237, v233, s35
  v_perm_b32 v122, v245, v241, s35
  v_perm_b32 v123, v253, v249, s35
  v_mfma_f32_16x16x32_bf16 v[52:55], v[80:83], v[112:115], v[52:55]
  v_perm_b32 v124, v229, v225, s60
  v_perm_b32 v125, v237, v233, s60
  v_perm_b32 v126, v245, v241, s60
  v_perm_b32 v127, v253, v249, s60
  v_mfma_f32_16x16x32_bf16 v[52:55], v[84:87], v[116:119], v[52:55]
  v_perm_b32 v112, v230, v226, s35
  v_perm_b32 v113, v238, v234, s35
  v_perm_b32 v114, v246, v242, s35
  v_perm_b32 v115, v254, v250, s35
  v_mfma_f32_16x16x32_bf16 v[52:55], v[88:91], v[120:123], v[52:55]
  v_perm_b32 v116, v230, v226, s60
  v_perm_b32 v117, v238, v234, s60
  v_perm_b32 v118, v246, v242, s60
  v_perm_b32 v119, v254, v250, s60
  v_mfma_f32_16x16x32_bf16 v[52:55], v[92:95], v[124:127], v[52:55]
  v_perm_b32 v120, v231, v227, s35
  v_perm_b32 v121, v239, v235, s35
  v_perm_b32 v122, v247, v243, s35
  v_perm_b32 v123, v255, v251, s35
  v_mfma_f32_16x16x32_bf16 v[52:55], v[96:99], v[112:115], v[52:55]
  v_perm_b32 v124, v231, v227, s60
  v_perm_b32 v125, v239, v235, s60
  v_perm_b32 v126, v247, v243, s60
  v_perm_b32 v127, v255, v251, s60
  v_mfma_f32_16x16x32_bf16 v[52:55], v[100:103], v[116:119], v[52:55]
  s_nop 0
  v_mfma_f32_16x16x32_bf16 v[52:55], v[104:107], v[120:123], v[52:55]
  s_nop 0
  v_mfma_f32_16x16x32_bf16 v[52:55], v[108:111], v[124:127], v[52:55]
  buffer_load_dwordx4 v[224:227], v6, s[12:15], s28 offen offset:256 nt
  buffer_load_dwordx4 v[228:231], v6, s[12:15], s28 offen offset:768 nt
  buffer_load_dwordx4 v[232:235], v6, s[12:15], s28 offen offset:1280 nt
  buffer_load_dwordx4 v[236:239], v6, s[12:15], s28 offen offset:1792 nt
  buffer_load_dwordx4 v[240:243], v7, s[12:15], s28 offen offset:256 nt
  buffer_load_dwordx4 v[244:247], v7, s[12:15], s28 offen offset:768 nt
  buffer_load_dwordx4 v[248:251], v7, s[12:15], s28 offen offset:1280 nt
  buffer_load_dwordx4 v[252:255], v7, s[12:15], s28 offen offset:1792 nt
  s_add_u32 s28, s28, 65536
  s_sub_u32 s40, s40, 1
  s_cmp_gt_u32 s40, 0
  s_cbranch_scc1 L_loop
L_last:
  s_waitcnt vmcnt(24)
  v_mfma_f32_16x16x32_bf16 v[56:59], v[128:131], v[16:19], 0
  v_mfma_f32_16x16x32_bf16 v[56:59], v[132:135], v[20:23], v[56:59]
  v_mfma_f32_16x16x32_bf16 v[56:59], v[136:139], v[24:27], v[56:59]
  v_mfma_f32_16x16x32_bf16 v[56:59], v[140:143], v[28:31], v[56:59]
  v_mfma_f32_16x16x32_bf16 v[56:59], v[144:147], v[32:35], v[56:59]
  v_mfma_f32_16x16x32_bf16 v[56:59], v[148:151], v[36:39], v[56:59]
  v_mfma_f32_16x16x32_bf16 v[56:59], v[152:155], v[40:43], v[56:59]
  v_mfma_f32_16x16x32_bf16 v[56:59], v[156:159], v[44:47], v[56:59]
  s_waitcnt vmcnt(16)
  v_mfma_f32_16x16x32_bf16 v[60:63], v[160:163], v[16:19], 0
  v_mfma_f32_16x16x32_bf16 v[60:63], v[164:167], v[20:23], v[60:63]
  v_mfma_f32_16x16x32_bf16 v[60:63], v[168:171], v[24:27], v[60:63]
  v_mfma_f32_16x16x32_bf16 v[60:63], v[172:175], v[28:31], v[60:63]
  v_mfma_f32_16x16x32_bf16 v[60:63], v[176:179], v[32:35], v[60:63]
  v_mfma_f32_16x16x32_bf16 v[60:63], v[180:183], v[36:39], v[60:63]
  v_mfma_f32_16x16x32_bf16 v[60:63], v[184:187], v[40:43], v[60:63]
  v_mfma_f32_16x16x32_bf16 v[60:63], v[188:191], v[44:47], v[60:63]
  s_nop 7
  v_cvt_pk_bf16_f32 v64, v56, v57
  v_cvt_pk_bf16_f32 v65, v58, v59
  v_cvt_pk_bf16_f32 v66, v60, v61
  v_cvt_pk_bf16_f32 v67, v62, v63
  v_lshlrev_b32 v56, 16, v64
  v_and_b32 v57, s86, v64
  v_lshlrev_b32 v58, 16, v65
  v_and_b32 v59, s86, v65
  v_lshlrev_b32 v60, 16, v66
  v_and_b32 v61, s86, v66
  v_lshlrev_b32 v62, 16, v67
  v_and_b32 v63, s86, v67
  v_max3_f32 v10, v56, v57, v58
  v_max3_f32 v11, v59, v60, v61
  v_max3_f32 v10, v10, v62, v63
  v_max_f32 v10, v10, v11
  v_mov_b32 v11, v10
  s_nop 1
  v_permlane16_swap_b32 v10, v11
  s_nop 0
  v_max_f32 v10, v10, v11
  v_mov_b32 v11, v10
  s_nop 1
  v_permlane32_swap_b32 v10, v11
  s_nop 0
  v_max_f32 v10, v10, v11
  v_max_f32 v10, v10, v76
  v_sub_f32 v78, v76, v10
  v_mul_f32 v78, s34, v78
  v_exp_f32 v78, v78
  v_mov_b32 v76, v10
  v_mul_f32 v79, s34, v10
  v_fma_f32 v56, v56, s34, -v79
  v_fma_f32 v57, v57, s34, -v79
  v_fma_f32 v58, v58, s34, -v79
  v_fma_f32 v59, v59, s34, -v79
  v_fma_f32 v60, v60, s34, -v79
  v_fma_f32 v61, v61, s34, -v79
  v_fma_f32 v62, v62, s34, -v79
  v_fma_f32 v63, v63, s34, -v79
  v_exp_f32 v56, v56
  v_exp_f32 v57, v57
  v_exp_f32 v58, v58
  v_exp_f32 v59, v59
  v_exp_f32 v60, v60
  v_exp_f32 v61, v61
  v_exp_f32 v62, v62
  v_exp_f32 v63, v63
  v_mul_f32_dpp v48, v78, v48 quad_perm:[0,0,2,2] row_mask:0xf bank_mask:0xf
  v_mul_f32_dpp v49, v78, v49 quad_perm:[1,1,3,3] row_mask:0xf bank_mask:0xf
  v_mul_f32_dpp v50, v78, v50 quad_perm:[0,0,2,2] row_mask:0xf bank_mask:0xf
  v_mul_f32_dpp v51, v78, v51 quad_perm:[1,1,3,3] row_mask:0xf bank_mask:0xf
  v_mul_f32_dpp v52, v78, v52 quad_perm:[0,0,2,2] row_mask:0xf bank_mask:0xf
  v_mul_f32_dpp v53, v78, v53 quad_perm:[1,1,3,3] row_mask:0xf bank_mask:0xf
  v_mul_f32_dpp v54, v78, v54 quad_perm:[0,0,2,2] row_mask:0xf bank_mask:0xf
  v_mul_f32_dpp v55, v78, v55 quad_perm:[1,1,3,3] row_mask:0xf bank_mask:0xf
  v_cvt_pk_bf16_f32 v64, v56, v57
  v_cvt_pk_bf16_f32 v65, v58, v59
  v_cvt_pk_bf16_f32 v66, v60, v61
  v_cvt_pk_bf16_f32 v67, v62, v63
  v_add_f32 v10, v56, v57
  v_add_f32 v11, v58, v59
  v_add_f32 v12, v60, v61
  v_add_f32 v13, v62, v63
  v_add_f32 v10, v10, v11
  v_add_f32 v12, v12, v13
  v_add_f32 v10, v10, v12
  v_fma_f32 v77, v77, v78, v10
  v_cndmask_b32 v80, 0, v64, s[64:65]
  v_cndmask_b32 v81, 0, v65, s[64:65]
  v_cndmask_b32 v82, 0, v66, s[64:65]
  v_cndmask_b32 v83, 0, v67, s[64:65]
  v_cndmask_b32 v84, 0, v64, s[66:67]
  v_cndmask_b32 v85, 0, v65, s[66:67]
  v_cndmask_b32 v86, 0, v66, s[66:67]
  v_cndmask_b32 v87, 0, v67, s[66:67]
  v_cndmask_b32 v88, 0, v64, s[68:69]
  v_cndmask_b32 v89, 0, v65, s[68:69]
  v_cndmask_b32 v90, 0, v66, s[68:69]
  v_cndmask_b32 v91, 0, v67, s[68:69]
  v_cndmask_b32 v92, 0, v64, s[70:71]
  v_cndmask_b32 v93, 0, v65, s[70:71]
  v_cndmask_b32 v94, 0, v66, s[70:71]
  v_cndmask_b32 v95, 0, v67, s[70:71]
  v_cndmask_b32 v96, 0, v64, s[72:73]
  v_cndmask_b32 v97, 0, v65, s[72:73]
  v_cndmask_b32 v98, 0, v66, s[72:73]
  v_cndmask_b32 v99, 0, v67, s[72:73]
  v_cndmask_b32 v100, 0, v64, s[74:75]
  v_cndmask_b32 v101, 0, v65, s[74:75]
  v_cndmask_b32 v102, 0, v66, s[74:75]
  v_cndmask_b32 v103, 0, v67, s[74:75]
  v_cndmask_b32 v104, 0, v64, s[76:77]
  v_cndmask_b32 v105, 0, v65, s[76:77]
  v_cndmask_b32 v106, 0, v66, s[76:77]
  v_cndmask_b32 v107, 0, v67, s[76:77]
  v_cndmask_b32 v108, 0, v64, s[78:79]
  v_cndmask_b32 v109, 0, v65, s[78:79]
  v_cndmask_b32 v110, 0, v66, s[78:79]
  v_cndmask_b32 v111, 0, v67, s[78:79]
  s_waitcnt vmcnt(8)
  v_perm_b32 v112, v196, v192, s35
  v_perm_b32 v113, v204, v200, s35
  v_perm_b32 v114, v212, v208, s35
  v_perm_b32 v115, v220, v216, s35
  v_perm_b32 v116, v196, v192, s60
  v_perm_b32 v117, v204, v200, s60
  v_perm_b32 v118, v212, v208, s60
  v_perm_b32 v119, v220, v216, s60
  v_perm_b32 v120, v197, v193, s35
  v_perm_b32 v121, v205, v201, s35
  v_perm_b32 v122, v213, v209, s35
  v_perm_b32 v123, v221, v217, s35
  v_mfma_f32_16x16x32_bf16 v[48:51], v[80:83], v[112:115], v[48:51]
  v_perm_b32 v124, v197, v193, s60
  v_perm_b32 v125, v205, v201, s60
  v_perm_b32 v126, v213, v209, s60
  v_perm_b32 v127, v221, v217, s60
  v_mfma_f32_16x16x32_bf16 v[48:51], v[84:87], v[116:119], v[48:51]
  v_perm_b32 v112, v198, v194, s35
  v_perm_b32 v113, v206, v202, s35
  v_perm_b32 v114, v214, v210, s35
  v_perm_b32 v115, v222, v218, s35
  v_mfma_f32_16x16x32_bf16 v[48:51], v[88:91], v[120:123], v[48:51]
  v_perm_b32 v116, v198, v194, s60
  v_perm_b32 v117, v206, v202, s60
  v_perm_b32 v118, v214, v210, s60
  v_perm_b32 v119, v222, v218, s60
  v_mfma_f32_16x16x32_bf16 v[48:51], v[92:95], v[124:127], v[48:51]
  v_perm_b32 v120, v199, v195, s35
  v_perm_b32 v121, v207, v203, s35
  v_perm_b32 v122, v215, v211, s35
  v_perm_b32 v123, v223, v219, s35
  v_mfma_f32_16x16x32_bf16 v[48:51], v[96:99], v[112:115], v[48:51]
  v_perm_b32 v124, v199, v195, s60
  v_perm_b32 v125, v207, v203, s60
  v_perm_b32 v126, v215, v211, s60
  v_perm_b32 v127, v223, v219, s60
  v_mfma_f32_16x16x32_bf16 v[48:51], v[100:103], v[116:119], v[48:51]
  s_nop 0
  v_mfma_f32_16x16x32_bf16 v[48:51], v[104:107], v[120:123], v[48:51]
  s_nop 0
  v_mfma_f32_16x16x32_bf16 v[48:51], v[108:111], v[124:127], v[48:51]
  s_waitcnt vmcnt(0)
  v_perm_b32 v112, v228, v224, s35
  v_perm_b32 v113, v236, v232, s35
  v_perm_b32 v114, v244, v240, s35
  v_perm_b32 v115, v252, v248, s35
  v_perm_b32 v116, v228, v224, s60
  v_perm_b32 v117, v236, v232, s60
  v_perm_b32 v118, v244, v240, s60
  v_perm_b32 v119, v252, v248, s60
  v_perm_b32 v120, v229, v225, s35
  v_perm_b32 v121, v237, v233, s35
  v_perm_b32 v122, v245, v241, s35
  v_perm_b32 v123, v253, v249, s35
  v_mfma_f32_16x16x32_bf16 v[52:55], v[80:83], v[112:115], v[52:55]
  v_perm_b32 v124, v229, v225, s60
  v_perm_b32 v125, v237, v233, s60
  v_perm_b32 v126, v245, v241, s60
  v_perm_b32 v127, v253, v249, s60
  v_mfma_f32_16x16x32_bf16 v[52:55], v[84:87], v[116:119], v[52:55]
  v_perm_b32 v112, v230, v226, s35
  v_perm_b32 v113, v238, v234, s35
  v_perm_b32 v114, v246, v242, s35
  v_perm_b32 v115, v254, v250, s35
  v_mfma_f32_16x16x32_bf16 v[52:55], v[88:91], v[120:123], v[52:55]
  v_perm_b32 v116, v230, v226, s60
  v_perm_b32 v117, v238, v234, s60
  v_perm_b32 v118, v246, v242, s60
  v_perm_b32 v119, v254, v250, s60
  v_mfma_f32_16x16x32_bf16 v[52:55], v[92:95], v[124:127], v[52:55]
  v_perm_b32 v120, v231, v227, s35
  v_perm_b32 v121, v239, v235, s35
  v_perm_b32 v122, v247, v243, s35
  v_perm_b32 v123, v255, v251, s35
  v_mfma_f32_16x16x32_bf16 v[52:55], v[96:99], v[112:115], v[52:55]
  v_perm_b32 v124, v231, v227, s60
  v_perm_b32 v125, v239, v235, s60
  v_perm_b32 v126, v247, v243, s60
  v_perm_b32 v127, v255, v251, s60
  v_mfma_f32_16x16x32_bf16 v[52:55], v[100:103], v[116:119], v[52:55]
  s_nop 0
  v_mfma_f32_16x16x32_bf16 v[52:55], v[104:107], v[120:123], v[52:55]
  s_nop 0
  v_mfma_f32_16x16x32_bf16 v[52:55], v[108:111], v[124:127], v[52:55]
  s_nop 7
  s_cmp_lt_u32 s3, 4
  s_cbranch_scc1 L_tail0
  s_cmp_eq_u32 s40, 257
  s_cbranch_scc1 L_wdma
  s_mov_b32 s40, 257
  s_lshl_b32 s80, s3, 2
  s_add_u32 s80, s80, 162816
  v_mov_b32 v10, s80
L_wl:
  ds_read_b32 v11, v10
  s_waitcnt lgkmcnt(0)
  v_cmp_eq_u32 vcc, 0, v11
  s_cbranch_vccz L_wl_ok
  s_sub_u32 s88, s88, 1
  s_cmp_eq_u32 s88, 0
  s_cbranch_scc1 L_end
  s_branch L_wl
L_wl_ok:
  s_sub_u32 s80, s3, 4
  s_lshl_b32 s80, s80, 15
  v_lshlrev_b32 v10, 4, v1
  v_add_u32 v10, s80, v10
  ds_read_b128 v[128:131], v10 offset:0
  ds_read_b128 v[132:135], v10 offset:1024
  ds_read_b128 v[136:139], v10 offset:2048
  ds_read_b128 v[140:143], v10 offset:3072
  ds_read_b128 v[144:147], v10 offset:4096
  ds_read_b128 v[148:151], v10 offset:5120
  ds_read_b128 v[152:155], v10 offset:6144
  ds_read_b128 v[156:159], v10 offset:7168
  ds_read_b128 v[160:163], v10 offset:8192
  ds_read_b128 v[164:167], v10 offset:9216
  ds_read_b128 v[168:171], v10 offset:10240
  ds_read_b128 v[172:175], v10 offset:11264
  ds_read_b128 v[176:179], v10 offset:12288
  ds_read_b128 v[180:183], v10 offset:13312
  ds_read_b128 v[184:187], v10 offset:14336
  ds_read_b128 v[188:191], v10 offset:15360
  ds_read_b128 v[192:195], v10 offset:16384
  ds_read_b128 v[196:199], v10 offset:17408
  ds_read_b128 v[200:203], v10 offset:18432
  ds_read_b128 v[204:207], v10 offset:19456
  ds_read_b128 v[208:211], v10 offset:20480
  ds_read_b128 v[212:215], v10 offset:21504
  ds_read_b128 v[216:219], v10 offset:22528
  ds_read_b128 v[220:223], v10 offset:23552
  ds_read_b128 v[224:227], v10 offset:24576
  ds_read_b128 v[228:231], v10 offset:25600
  ds_read_b128 v[232:235], v10 offset:26624
  ds_read_b128 v[236:239], v10 offset:27648
  ds_read_b128 v[240:243], v10 offset:28672
  ds_read_b128 v[244:247], v10 offset:29696
  ds_read_b128 v[248:251], v10 offset:30720
  ds_read_b128 v[252:255], v10 offset:31744
  s_waitcnt lgkmcnt(0)
  v_mov_b32 v10, 162816
  v_mov_b32 v11, 1
  s_mov_b64 exec, 1
  ds_add_u32 v10, v11 offset:32
  s_mov_b64 exec, -1
  s_branch L_last
L_wdma:
  v_mov_b32 v10, 162816
L_wfw:
  ds_read_b32 v11, v10 offset:32
  s_waitcnt lgkmcnt(0)
  v_cmp_gt_u32 vcc, 4, v11
  s_cbranch_vccz L_wfw_ok
  s_sub_u32 s88, s88, 1
  s_cmp_eq_u32 s88, 0
  s_cbranch_scc1 L_end
  s_branch L_wfw
L_wfw_ok:
  s_setprio 2
  s_cmp_eq_u32 s3, 7
  s_cbranch_scc0 L_nocert
  s_mov_b32 s20, s56
  s_and_b32 s21, s57, 0xffff
  s_mov_b32 s22, 256
  s_mov_b32 s23, 0x20000
  v_lshlrev_b32 v10, 5, v1
  s_mov_b64 exec, 0xff
L_cert:
  buffer_load_dword v11, v10, s[20:23], 0 offen sc1
  s_waitcnt vmcnt(0)
  v_cmp_gt_u32 vcc, 32, v11
  s_cbranch_vccz L_cert_ok
  s_sub_u32 s88, s88, 1
  s_cmp_eq_u32 s88, 0
  s_cbranch_scc1 L_end
  s_branch L_cert
L_cert_ok:
  s_mov_b64 exec, -1
L_nocert:
  s_sub_u32 s82, s3, 4
  s_cmp_ge_u32 s62, 56
  s_cbranch_scc1 L_nowd
  s_mov_b32 s20, s52
  s_and_b32 s21, s53, 0xffff
  s_mov_b32 s22, 1605632
  s_mov_b32 s23, 0x20000
  v_mul_u32_u24 v10, 896, v1
  s_mul_i32 s80, s82, 401408
  s_lshl_b32 s81, s62, 4
  s_add_u32 s80, s80, s81
  s_mul_i32 s81, s82, 7168
  s_add_u32 s81, s81, 114688
  s_mov_b32 m0, s81
  s_add_u32 s81, s81, 1024
  buffer_load_dwordx4 v10, s[20:23], s80 offen  lds
  s_add_u32 s80, s80, 57344
  s_mov_b32 m0, s81
  s_add_u32 s81, s81, 1024
  buffer_load_dwordx4 v10, s[20:23], s80 offen  lds
  s_add_u32 s80, s80, 57344
  s_mov_b32 m0, s81
  s_add_u32 s81, s81, 1024
  buffer_load_dwordx4 v10, s[20:23], s80 offen  lds
  s_add_u32 s80, s80, 57344
  s_mov_b32 m0, s81
  s_add_u32 s81, s81, 1024
  buffer_load_dwordx4 v10, s[20:23], s80 offen  lds
  s_add_u32 s80, s80, 57344
  s_mov_b32 m0, s81
  s_add_u32 s81, s81, 1024
  buffer_load_dwordx4 v10, s[20:23], s80 offen  lds
  s_add_u32 s80, s80, 57344
  s_mov_b32 m0, s81
  s_add_u32 s81, s81, 1024
  buffer_load_dwordx4 v10, s[20:23], s80 offen  lds
  s_add_u32 s80, s80, 57344
  s_mov_b32 m0, s81
  s_add_u32 s81, s81, 1024
  buffer_load_dwordx4 v10, s[20:23], s80 offen  lds
  s_add_u32 s80, s80, 57344
L_nowd:
  s_cmp_ge_u32 s61, 112
  s_cbranch_scc1 L_nogu
  s_cmp_ge_u32 s82, 2
  s_cselect_b32 s20, s50, s48
  s_cselect_b32 s21, s51, s49
  s_and_b32 s21, s21, 0xffff
  s_mov_b32 s22, 1605632
  s_mov_b32 s23, 0x20000
  v_lshrrev_b32 v10, 1, v1
  v_mul_u32_u24 v10, 3584, v10
  v_and_b32 v11, 1, v1
  v_lshl_add_u32 v10, v11, 4, v10
  s_and_b32 s80, s82, 1
  s_mul_i32 s80, s80, 802816
  s_lshl_b32 s81, s61, 5
  s_add_u32 s80, s80, s81
  s_mul_i32 s81, s82, 7168
  s_add_u32 s81, s81, 114688
  s_mov_b32 m0, s81
  s_add_u32 s81, s81, 1024
  buffer_load_dwordx4 v10, s[20:23], s80 offen  lds
  s_add_u32 s80, s80, 114688
  s_mov_b32 m0, s81
  s_add_u32 s81, s81, 1024
  buffer_load_dwordx4 v10, s[20:23], s80 offen  lds
  s_add_u32 s80, s80, 114688
  s_mov_b32 m0, s81
  s_add_u32 s81, s81, 1024
  buffer_load_dwordx4 v10, s[20:23], s80 offen  lds
  s_add_u32 s80, s80, 114688
  s_mov_b32 m0, s81
  s_add_u32 s81, s81, 1024
  buffer_load_dwordx4 v10, s[20:23], s80 offen  lds
  s_add_u32 s80, s80, 114688
  s_mov_b32 m0, s81
  s_add_u32 s81, s81, 1024
  buffer_load_dwordx4 v10, s[20:23], s80 offen  lds
  s_add_u32 s80, s80, 114688
  s_mov_b32 m0, s81
  s_add_u32 s81, s81, 1024
  buffer_load_dwordx4 v10, s[20:23], s80 offen  lds
  s_add_u32 s80, s80, 114688
  s_mov_b32 m0, s81
  s_add_u32 s81, s81, 1024
  buffer_load_dwordx4 v10, s[20:23], s80 offen  lds
  s_add_u32 s80, s80, 114688
L_nogu:
  s_sub_u32 s82, s3, 4
  s_mov_b32 s20, s44
  s_and_b32 s21, s45, 0xffff
  s_mov_b32 s22, 3670016
  s_mov_b32 s23, 0x20000
  v_lshrrev_b32 v10, 3, v1
  v_bfe_u32 v11, v1, 1, 2
  v_lshrrev_b32 v12, 4, v1
  v_xor_b32 v11, v11, v12
  v_mul_u32_u24 v10, 896, v10
  v_and_b32 v12, 1, v1
  v_lshl_add_u32 v10, v12, 4, v10
  v_lshl_add_u32 v12, v11, 5, v10
  v_xor_b32 v11, 2, v11
  v_lshl_add_u32 v13, v11, 5, v10
  s_lshl_b32 s80, s87, 7
  s_lshl_b32 s81, s82, 5
  s_add_u32 s80, s80, s81
  s_mul_i32 s80, s80, 896
  s_mul_i32 s81, s82, 28672
  s_mov_b32 m0, s81
  s_add_u32 s81, s81, 1024
  buffer_load_dwordx4 v12, s[20:23], s80 offen  lds
  s_add_u32 s80, s80, 128
  s_mov_b32 m0, s81
  s_add_u32 s81, s81, 1024
  buffer_load_dwordx4 v12, s[20:23], s80 offen  lds
  s_add_u32 s80, s80, 128
  s_mov_b32 m0, s81
  s_add_u32 s81, s81, 1024
  buffer_load_dwordx4 v12, s[20:23], s80 offen  lds
  s_add_u32 s80, s80, 128
  s_mov_b32 m0, s81
  s_add_u32 s81, s81, 1024
  buffer_load_dwordx4 v12, s[20:23], s80 offen  lds
  s_add_u32 s80, s80, 128
  s_mov_b32 m0, s81
  s_add_u32 s81, s81, 1024
  buffer_load_dwordx4 v12, s[20:23], s80 offen  lds
  s_add_u32 s80, s80, 128
  s_mov_b32 m0, s81
  s_add_u32 s81, s81, 1024
  buffer_load_dwordx4 v12, s[20:23], s80 offen  lds
  s_add_u32 s80, s80, 128
  s_mov_b32 m0, s81
  s_add_u32 s81, s81, 1024
  buffer_load_dwordx4 v12, s[20:23], s80 offen  lds
  s_add_u32 s80, s80, 6400
  s_mov_b32 m0, s81
  s_add_u32 s81, s81, 1024
  buffer_load_dwordx4 v13, s[20:23], s80 offen  lds
  s_add_u32 s80, s80, 128
  s_mov_b32 m0, s81
  s_add_u32 s81, s81, 1024
  buffer_load_dwordx4 v13, s[20:23], s80 offen  lds
  s_add_u32 s80, s80, 128
  s_mov_b32 m0, s81
  s_add_u32 s81, s81, 1024
  buffer_load_dwordx4 v13, s[20:23], s80 offen  lds
  s_add_u32 s80, s80, 128
  s_mov_b32 m0, s81
  s_add_u32 s81, s81, 1024
  buffer_load_dwordx4 v13, s[20:23], s80 offen  lds
  s_add_u32 s80, s80, 128
  s_mov_b32 m0, s81
  s_add_u32 s81, s81, 1024
  buffer_load_dwordx4 v13, s[20:23], s80 offen  lds
  s_add_u32 s80, s80, 128
  s_mov_b32 m0, s81
  s_add_u32 s81, s81, 1024
  buffer_load_dwordx4 v13, s[20:23], s80 offen  lds
  s_add_u32 s80, s80, 128
  s_mov_b32 m0, s81
  s_add_u32 s81, s81, 1024
  buffer_load_dwordx4 v13, s[20:23], s80 offen  lds
  s_add_u32 s80, s80, 6400
  s_mov_b32 m0, s81
  s_add_u32 s81, s81, 1024
  buffer_load_dwordx4 v12, s[20:23], s80 offen  lds
  s_add_u32 s80, s80, 128
  s_mov_b32 m0, s81
  s_add_u32 s81, s81, 1024
  buffer_load_dwordx4 v12, s[20:23], s80 offen  lds
  s_add_u32 s80, s80, 128
  s_mov_b32 m0, s81
  s_add_u32 s81, s81, 1024
  buffer_load_dwordx4 v12, s[20:23], s80 offen  lds
  s_add_u32 s80, s80, 128
  s_mov_b32 m0, s81
  s_add_u32 s81, s81, 1024
  buffer_load_dwordx4 v12, s[20:23], s80 offen  lds
  s_add_u32 s80, s80, 128
  s_mov_b32 m0, s81
  s_add_u32 s81, s81, 1024
  buffer_load_dwordx4 v12, s[20:23], s80 offen  lds
  s_add_u32 s80, s80, 128
  s_mov_b32 m0, s81
  s_add_u32 s81, s81, 1024
  buffer_load_dwordx4 v12, s[20:23], s80 offen  lds
  s_add_u32 s80, s80, 128
  s_mov_b32 m0, s81
  s_add_u32 s81, s81, 1024
  buffer_load_dwordx4 v12, s[20:23], s80 offen  lds
  s_add_u32 s80, s80, 6400
  s_mov_b32 m0, s81
  s_add_u32 s81, s81, 1024
  buffer_load_dwordx4 v13, s[20:23], s80 offen  lds
  s_add_u32 s80, s80, 128
  s_mov_b32 m0, s81
  s_add_u32 s81, s81, 1024
  buffer_load_dwordx4 v13, s[20:23], s80 offen  lds
  s_add_u32 s80, s80, 128
  s_mov_b32 m0, s81
  s_add_u32 s81, s81, 1024
  buffer_load_dwordx4 v13, s[20:23], s80 offen  lds
  s_add_u32 s80, s80, 128
  s_mov_b32 m0, s81
  s_add_u32 s81, s81, 1024
  buffer_load_dwordx4 v13, s[20:23], s80 offen  lds
  s_add_u32 s80, s80, 128
  s_mov_b32 m0, s81
  s_add_u32 s81, s81, 1024
  buffer_load_dwordx4 v13, s[20:23], s80 offen  lds
  s_add_u32 s80, s80, 128
  s_mov_b32 m0, s81
  s_add_u32 s81, s81, 1024
  buffer_load_dwordx4 v13, s[20:23], s80 offen  lds
  s_add_u32 s80, s80, 128
  s_mov_b32 m0, s81
  s_add_u32 s81, s81, 1024
  buffer_load_dwordx4 v13, s[20:23], s80 offen  lds
  s_add_u32 s80, s80, 6400
  s_waitcnt vmcnt(0)
  s_setprio 0
L_tail0:
  v_mov_b32 v10, v77
  s_nop 1
  v_permlane16_swap_b32 v77, v10
  s_nop 0
  v_add_f32 v77, v77, v10
  v_mov_b32 v10, v77
  s_nop 1
  v_permlane32_swap_b32 v77, v10
  s_nop 0
  v_add_f32 v77, v77, v10
  v_lshlrev_b32 v10, 5, v2
  v_lshl_add_u32 v10, v3, 3, v10
  s_lshl_b32 s80, s3, 11
  s_add_u32 s80, s80, 143360
  v_add_u32 v10, s80, v10
  v_add_u32 v11, 1024, v10
  ds_write2_b32 v10, v48, v50 offset0:0 offset1:1
  ds_write2_b32 v11, v49, v51 offset0:0 offset1:1
  ds_write2_b32 v10, v52, v54 offset0:128 offset1:129
  ds_write2_b32 v11, v53, v55 offset0:128 offset1:129
  s_lshl_b32 s80, s3, 4
  s_add_u32 s80, s80, 159744
  v_lshlrev_b32 v12, 3, v1
  v_add_u32 v12, s80, v12
  s_mov_b64 exec, 3
  ds_write_b64 v12, v[76:77]
  s_mov_b64 exec, -1
  v_lshlrev_b32 v10, 2, v0
  v_add_u32 v10, 143360, v10
  v_lshrrev_b32 v11, 8, v0
  v_lshlrev_b32 v11, 3, v11
  v_add_u32 v11, 159744, v11
  v_bfe_u32 v12, v1, 2, 2
  v_lshrrev_b32 v13, 1, v12
  v_and_b32 v14, 1, v3
  v_lshlrev_b32 v14, 1, v14
  v_xor_b32 v13, v13, v14
  s_and_b32 s80, s3, 3
  v_xor_b32 v13, s80, v13
  v_mul_u32_u24 v14, 7168, v3
  v_lshl_add_u32 v14, v12, 7, v14
  v_and_b32 v12, 3, v1
  v_lshl_add_u32 v14, v12, 3, v14
  s_lshr_b32 s80, s3, 2
  s_lshl_b32 s80, s80, 10
  v_add_u32 v14, s80, v14
  v_lshl_add_u32 v80, v13, 5, v14
  v_xor_b32 v13, 2, v13
  v_lshl_add_u32 v81, v13, 5, v14
  v_add_u32 v81, 512, v81
  v_add_u32 v82, 57344, v80
  v_add_u32 v83, 57344, v81
  s_waitcnt lgkmcnt(0)
  s_barrier
  ds_read_b64 v[16:17], v11 offset:0
  ds_read_b64 v[18:19], v11 offset:16
  ds_read_b64 v[20:21], v11 offset:32
  ds_read_b64 v[22:23], v11 offset:48
  ds_read_b64 v[24:25], v11 offset:64
  ds_read_b64 v[26:27], v11 offset:80
  ds_read_b64 v[28:29], v11 offset:96
  ds_read_b64 v[30:31], v11 offset:112
  ds_read_b32 v32, v10 offset:0
  ds_read_b32 v33, v10 offset:2048
  ds_read_b32 v34, v10 offset:4096
  ds_read_b32 v35, v10 offset:6144
  ds_read_b32 v36, v10 offset:8192
  ds_read_b32 v37, v10 offset:10240
  ds_read_b32 v38, v10 offset:12288
  ds_read_b32 v39, v10 offset:14336
  s_waitcnt lgkmcnt(8)
  v_max3_f32 v10, v16, v18, v20
  v_max3_f32 v11, v22, v24, v26
  v_max3_f32 v10, v10, v28, v30
  v_max_f32 v10, v10, v11
  v_sub_f32 v16, v16, v10
  v_sub_f32 v18, v18, v10
  v_sub_f32 v20, v20, v10
  v_sub_f32 v22, v22, v10
  v_sub_f32 v24, v24, v10
  v_sub_f32 v26, v26, v10
  v_sub_f32 v28, v28, v10
  v_sub_f32 v30, v30, v10
  v_mul_f32 v16, s34, v16
  v_mul_f32 v18, s34, v18
  v_mul_f32 v20, s34, v20
  v_mul_f32 v22, s34, v22
  v_mul_f32 v24, s34, v24
  v_mul_f32 v26, s34, v26
  v_mul_f32 v28, s34, v28
  v_mul_f32 v30, s34, v30
  v_exp_f32 v16, v16
  v_exp_f32 v18, v18
  v_exp_f32 v20, v20
  v_exp_f32 v22, v22
  v_exp_f32 v24, v24
  v_exp_f32 v26, v26
  v_exp_f32 v28, v28
  v_exp_f32 v30, v30
  s_waitcnt lgkmcnt(0)
  v_mul_f32 v11, v16, v17
  v_mul_f32 v12, v16, v32
  v_fma_f32 v11, v18, v19, v11
  v_fma_f32 v12, v18, v33, v12
  v_fma_f32 v11, v20, v21, v11
  v_fma_f32 v12, v20, v34, v12
  v_fma_f32 v11, v22, v23, v11
  v_fma_f32 v12, v22, v35, v12
  v_fma_f32 v11, v24, v25, v11
  v_fma_f32 v12, v24, v36, v12
  v_fma_f32 v11, v26, v27, v11
  v_fma_f32 v12, v26, v37, v12
  v_fma_f32 v11, v28, v29, v11
  v_fma_f32 v12, v28, v38, v12
  v_fma_f32 v11, v30, v31, v11
  v_fma_f32 v12, v30, v39, v12
  v_rcp_f32 v13, v11
  v_log_f32 v14, v11
  s_mul_i32 s80, s32, 508
  s_sub_u32 s80, 2048, s80
  v_mul_f32 v40, v12, v13
  v_fma_f32 v42, v10, s34, v14
  v_min_u32 v40, 0xfffffffe, v40
  v_min_u32 v42, 0xfffffffe, v42
  buffer_store_dword v40, v8, s[16:19], 0 offen sc1
  v_and_b32 v11, 127, v0
  v_cmp_eq_u32 vcc, 0, v11
  s_and_saveexec_b64 s[84:85], vcc
  s_cbranch_execz L_t1s
  buffer_store_dword v42, v8, s[16:19], s80 offen sc1
L_t1s:
  s_mov_b64 exec, s[84:85]
  ds_read_b64_tr_b16 v[128:129], v80 offset:0
  ds_read_b64_tr_b16 v[130:131], v81 offset:0
  ds_read_b64_tr_b16 v[132:133], v80 offset:28672
  ds_read_b64_tr_b16 v[134:135], v81 offset:28672
  ds_read_b64_tr_b16 v[136:137], v82 offset:0
  ds_read_b64_tr_b16 v[138:139], v83 offset:0
  ds_read_b64_tr_b16 v[140:141], v82 offset:28672
  ds_read_b64_tr_b16 v[142:143], v83 offset:28672
  ds_read_b64_tr_b16 v[144:145], v80 offset:2048
  ds_read_b64_tr_b16 v[146:147], v81 offset:2048
  ds_read_b64_tr_b16 v[148:149], v80 offset:30720
  ds_read_b64_tr_b16 v[150:151], v81 offset:30720
  ds_read_b64_tr_b16 v[152:153], v82 offset:2048
  ds_read_b64_tr_b16 v[154:155], v83 offset:2048
  ds_read_b64_tr_b16 v[156:157], v82 offset:30720
  ds_read_b64_tr_b16 v[158:159], v83 offset:30720
  ds_read_b64_tr_b16 v[160:161], v80 offset:4096
  ds_read_b64_tr_b16 v[162:163], v81 offset:4096
  ds_read_b64_tr_b16 v[164:165], v80 offset:32768
  ds_read_b64_tr_b16 v[166:167], v81 offset:32768
  ds_read_b64_tr_b16 v[168:169], v82 offset:4096
  ds_read_b64_tr_b16 v[170:171], v83 offset:4096
  ds_read_b64_tr_b16 v[172:173], v82 offset:32768
  ds_read_b64_tr_b16 v[174:175], v83 offset:32768
  ds_read_b64_tr_b16 v[176:177], v80 offset:6144
  ds_read_b64_tr_b16 v[178:179], v81 offset:6144
  ds_read_b64_tr_b16 v[180:181], v80 offset:34816
  ds_read_b64_tr_b16 v[182:183], v81 offset:34816
  ds_read_b64_tr_b16 v[184:185], v82 offset:6144
  ds_read_b64_tr_b16 v[186:187], v83 offset:6144
  ds_read_b64_tr_b16 v[188:189], v82 offset:34816
  ds_read_b64_tr_b16 v[190:191], v83 offset:34816
  s_lshl_b32 s82, s2, 13
  s_add_u32 s82, s82, 0x100000
  s_cmp_ge_u32 s3, 2
  s_cbranch_scc1 L_t2b
  v_lshlrev_b32 v10, 2, v0
  v_mov_b32 v11, 2048
L_p1:
  buffer_load_dword v16, v10, s[16:19], s82 offen offset:0 sc1
  buffer_load_dword v17, v10, s[16:19], s82 offen offset:512 sc1
  buffer_load_dword v18, v10, s[16:19], s82 offen offset:1024 sc1
  buffer_load_dword v19, v10, s[16:19], s82 offen offset:1536 sc1
  buffer_load_dwordx4 v[24:27], v11, s[16:19], s82 offen sc1
  s_waitcnt vmcnt(0)
  v_max3_u32 v12, v16, v17, v18
  v_max3_u32 v13, v19, v24, v25
  v_max3_u32 v12, v12, v26, v27
  v_max_u32 v12, v12, v13
  v_cmp_eq_u32 vcc, -1, v12
  s_cbranch_vccz L_p1_ok
  s_sub_u32 s88, s88, 1
  s_cmp_eq_u32 s88, 0
  s_cbranch_scc1 L_end
  s_branch L_p1
L_p1_ok:
  v_max3_f32 v12, v24, v25, v26
  v_max_f32 v12, v12, v27
  v_sub_f32 v24, v24, v12
  v_sub_f32 v25, v25, v12
  v_sub_f32 v26, v26, v12
  v_sub_f32 v27, v27, v12
  v_exp_f32 v24, v24
  v_exp_f32 v25, v25
  v_exp_f32 v26, v26
  v_exp_f32 v27, v27
  v_lshlrev_b32 v10, 1, v0
  v_add_f32 v12, v24, v25
  v_add_f32 v13, v26, v27
  v_add_f32 v12, v12, v13
  v_rcp_f32 v12, v12
  v_mul_f32 v13, v24, v16
  v_fma_f32 v13, v25, v17, v13
  v_fma_f32 v13, v26, v18, v13
  v_fma_f32 v13, v27, v19, v13
  v_mul_f32 v13, v13, v12
  v_cvt_pk_bf16_f32 v13, v13, v13
  v_add_u32 v11, 159872, v10
  ds_write_b16 v11, v13
L_t2b:
  v_lshlrev_b32 v10, 4, v3
  v_add_u32 v10, 159872, v10
  v_cmp_eq_u32 vcc, 1, v3
  v_cmp_eq_u32 s[80:81], 2, v3
  v_cmp_eq_u32 s[84:85], 3, v3
  s_waitcnt lgkmcnt(0)
  s_barrier
  ds_read_b128 v[16:19], v10 offset:0
  ds_read_b128 v[20:23], v10 offset:64
  ds_read_b128 v[24:27], v10 offset:128
  ds_read_b128 v[28:31], v10 offset:192
  v_lshlrev_b32 v10, 2, v0
  v_add_u32 v10, 2304, v10
  s_waitcnt lgkmcnt(3)
  v_mfma_f32_16x16x32_bf16 v[32:35], v[16:19], v[128:131], 0
  v_mfma_f32_16x16x32_bf16 v[36:39], v[16:19], v[144:147], 0
  v_mfma_f32_16x16x32_bf16 v[40:43], v[16:19], v[160:163], 0
  v_mfma_f32_16x16x32_bf16 v[44:47], v[16:19], v[176:179], 0
  s_waitcnt lgkmcnt(2)
  v_mfma_f32_16x16x32_bf16 v[32:35], v[20:23], v[132:135], v[32:35]
  v_mfma_f32_16x16x32_bf16 v[36:39], v[20:23], v[148:151], v[36:39]
  v_mfma_f32_16x16x32_bf16 v[40:43], v[20:23], v[164:167], v[40:43]
  v_mfma_f32_16x16x32_bf16 v[44:47], v[20:23], v[180:183], v[44:47]
  s_waitcnt lgkmcnt(1)
  v_mfma_f32_16x16x32_bf16 v[32:35], v[24:27], v[136:139], v[32:35]
  v_mfma_f32_16x16x32_bf16 v[36:39], v[24:27], v[152:155], v[36:39]
  v_mfma_f32_16x16x32_bf16 v[40:43], v[24:27], v[168:171], v[40:43]
  v_mfma_f32_16x16x32_bf16 v[44:47], v[24:27], v[184:187], v[44:47]
  s_waitcnt lgkmcnt(0)
  v_mfma_f32_16x16x32_bf16 v[32:35], v[28:31], v[140:143], v[32:35]
  v_mfma_f32_16x16x32_bf16 v[36:39], v[28:31], v[156:159], v[36:39]
  v_mfma_f32_16x16x32_bf16 v[40:43], v[28:31], v[172:175], v[40:43]
  v_mfma_f32_16x16x32_bf16 v[44:47], v[28:31], v[188:191], v[44:47]
  s_nop 7
  v_cndmask_b32 v48, v32, v36, vcc
  v_cndmask_b32 v48, v48, v40, s[80:81]
  v_cndmask_b32 v48, v48, v44, s[84:85]
  v_min_u32 v48, 0xfffffffe, v48
  buffer_store_dword v48, v9, s[16:19], 0 offen sc1
  v_bfe_u32 v13, v1, 2, 2
  v_and_b32 v14, 3, v1
  s_cmp_ge_u32 s61, 112
  s_cbranch_scc1 L_plwd
  s_cmp_eq_u32 s3, 7
  s_cbranch_scc0 L_pldone
  v_lshlrev_b32 v15, 8, v3
  v_lshl_add_u32 v15, v13, 5, v15
  v_lshl_add_u32 v15, v14, 3, v15
  v_add_u32 v15, 114688, v15
  ds_read_b64_tr_b16 v[128:129], v15 offset:0
  ds_read_b64_tr_b16 v[130:131], v15 offset:128
  ds_read_b64_tr_b16 v[132:133], v15 offset:1024
  ds_read_b64_tr_b16 v[134:135], v15 offset:1152
  ds_read_b64_tr_b16 v[136:137], v15 offset:2048
  ds_read_b64_tr_b16 v[138:139], v15 offset:2176
  ds_read_b64_tr_b16 v[140:141], v15 offset:3072
  ds_read_b64_tr_b16 v[142:143], v15 offset:3200
  ds_read_b64_tr_b16 v[144:145], v15 offset:4096
  ds_read_b64_tr_b16 v[146:147], v15 offset:4224
  ds_read_b64_tr_b16 v[148:149], v15 offset:5120
  ds_read_b64_tr_b16 v[150:151], v15 offset:5248
  ds_read_b64_tr_b16 v[152:153], v15 offset:6144
  ds_read_b64_tr_b16 v[154:155], v15 offset:6272
  ds_read_b64_tr_b16 v[156:157], v15 offset:7168
  ds_read_b64_tr_b16 v[158:159], v15 offset:7296
  ds_read_b64_tr_b16 v[160:161], v15 offset:8192
  ds_read_b64_tr_b16 v[162:163], v15 offset:8320
  ds_read_b64_tr_b16 v[164:165], v15 offset:9216
  ds_read_b64_tr_b16 v[166:167], v15 offset:9344
  ds_read_b64_tr_b16 v[168:169], v15 offset:10240
  ds_read_b64_tr_b16 v[170:171], v15 offset:10368
  ds_read_b64_tr_b16 v[172:173], v15 offset:11264
  ds_read_b64_tr_b16 v[174:175], v15 offset:11392
  ds_read_b64_tr_b16 v[176:177], v15 offset:12288
  ds_read_b64_tr_b16 v[178:179], v15 offset:12416
  ds_read_b64_tr_b16 v[180:181], v15 offset:13312
  ds_read_b64_tr_b16 v[182:183], v15 offset:13440
  ds_read_b64_tr_b16 v[184:185], v15 offset:14336
  ds_read_b64_tr_b16 v[186:187], v15 offset:14464
  ds_read_b64_tr_b16 v[188:189], v15 offset:15360
  ds_read_b64_tr_b16 v[190:191], v15 offset:15488
  ds_read_b64_tr_b16 v[192:193], v15 offset:16384
  ds_read_b64_tr_b16 v[194:195], v15 offset:16512
  ds_read_b64_tr_b16 v[196:197], v15 offset:17408
  ds_read_b64_tr_b16 v[198:199], v15 offset:17536
  ds_read_b64_tr_b16 v[200:201], v15 offset:18432
  ds_read_b64_tr_b16 v[202:203], v15 offset:18560
  ds_read_b64_tr_b16 v[204:205], v15 offset:19456
  ds_read_b64_tr_b16 v[206:207], v15 offset:19584
  ds_read_b64_tr_b16 v[208:209], v15 offset:20480
  ds_read_b64_tr_b16 v[210:211], v15 offset:20608
  ds_read_b64_tr_b16 v[212:213], v15 offset:21504
  ds_read_b64_tr_b16 v[214:215], v15 offset:21632
  ds_read_b64_tr_b16 v[216:217], v15 offset:22528
  ds_read_b64_tr_b16 v[218:219], v15 offset:22656
  ds_read_b64_tr_b16 v[220:221], v15 offset:23552
  ds_read_b64_tr_b16 v[222:223], v15 offset:23680
  ds_read_b64_tr_b16 v[224:225], v15 offset:24576
  ds_read_b64_tr_b16 v[226:227], v15 offset:24704
  ds_read_b64_tr_b16 v[228:229], v15 offset:25600
  ds_read_b64_tr_b16 v[230:231], v15 offset:25728
  ds_read_b64_tr_b16 v[232:233], v15 offset:26624
  ds_read_b64_tr_b16 v[234:235], v15 offset:26752
  ds_read_b64_tr_b16 v[236:237], v15 offset:27648
  ds_read_b64_tr_b16 v[238:239], v15 offset:27776
  s_branch L_pldone
L_plwd:
  s_cmp_ge_u32 s62, 56
  s_cbranch_scc1 L_pldone
  v_lshlrev_b32 v15, 7, v3
  v_lshl_add_u32 v15, v13, 4, v15
  v_lshl_add_u32 v15, v14, 3, v15
  s_mul_i32 s80, s3, 3584
  s_add_u32 s80, s80, 114688
  v_add_u32 v15, s80, v15
  ds_read_b64_tr_b16 v[128:129], v15 offset:0
  ds_read_b64_tr_b16 v[130:131], v15 offset:64
  ds_read_b64_tr_b16 v[132:133], v15 offset:512
  ds_read_b64_tr_b16 v[134:135], v15 offset:576
  ds_read_b64_tr_b16 v[136:137], v15 offset:1024
  ds_read_b64_tr_b16 v[138:139], v15 offset:1088
  ds_read_b64_tr_b16 v[140:141], v15 offset:1536
  ds_read_b64_tr_b16 v[142:143], v15 offset:1600
  ds_read_b64_tr_b16 v[144:145], v15 offset:2048
  ds_read_b64_tr_b16 v[146:147], v15 offset:2112
  ds_read_b64_tr_b16 v[148:149], v15 offset:2560
  ds_read_b64_tr_b16 v[150:151], v15 offset:2624
  ds_read_b64_tr_b16 v[152:153], v15 offset:3072
  ds_read_b64_tr_b16 v[154:155], v15 offset:3136
L_pldone:
  s_cmp_eq_u32 s3, 0
  s_cbranch_scc0 L_t5
  v_cmp_gt_u32 s[80:81], 14, v2
  v_lshlrev_b32 v10, 9, v3
  v_lshl_add_u32 v10, v2, 2, v10
  v_add_u32 v10, 2304, v10
  v_lshlrev_b32 v15, 1, v2
  s_lshl_b32 s83, s2, 5
  s_add_u32 s83, s83, 0x400000
  v_lshlrev_b32 v68, 16, v68
L_p2:
  buffer_load_dword v16, v10, s[16:19], s82 offen offset:0 sc1
  buffer_load_dword v17, v10, s[16:19], s82 offen offset:64 sc1
  buffer_load_dword v18, v10, s[16:19], s82 offen offset:128 sc1
  buffer_load_dword v19, v10, s[16:19], s82 offen offset:192 sc1
  buffer_load_dword v20, v10, s[16:19], s82 offen offset:256 sc1
  buffer_load_dword v21, v10, s[16:19], s82 offen offset:320 sc1
  buffer_load_dword v22, v10, s[16:19], s82 offen offset:384 sc1
  buffer_load_dword v23, v10, s[16:19], s82 offen offset:448 sc1
  s_waitcnt vmcnt(0)
  v_max3_u32 v11, v16, v17, v18
  v_max3_u32 v12, v19, v20, v21
  v_max3_u32 v11, v11, v22, v23
  v_max_u32 v11, v11, v12
  v_cmp_eq_u32 vcc, -1, v11
  v_add_f32 v16, v16, v17
  v_add_f32 v18, v18, v19
  v_add_f32 v20, v20, v21
  v_add_f32 v22, v22, v23
  s_and_b64 vcc, vcc, s[80:81]
  s_cbranch_scc0 L_p2_ok
  s_sub_u32 s88, s88, 1
  s_cmp_eq_u32 s88, 0
  s_cbranch_scc1 L_end
  s_branch L_p2
L_p2_ok:
  v_add_f32 v16, v16, v18
  v_add_f32 v20, v20, v22
  v_add_f32 v16, v16, v20
  v_mov_b32 v18, v16
  s_nop 1
  v_permlane16_swap_b32 v16, v18
  s_nop 0
  v_add_f32 v16, v16, v18
  v_mov_b32 v18, v16
  s_nop 1
  v_permlane32_swap_b32 v16, v18
  s_nop 0
  v_add_f32 v16, v16, v18
  v_cvt_pk_bf16_f32 v16, v16, v16
  v_lshlrev_b32 v16, 16, v16
  v_add_f32 v16, v16, v68
  s_nop 1
  v_mov_b32_dpp v17, v16 quad_perm:[1,1,3,3] row_mask:0xf bank_mask:0xf
  v_cvt_pk_bf16_f32 v16, v16, v17
  v_min_u32 v16, 0xfffffffe, v16
  s_mov_b64 exec, 0x1555
  buffer_store_dword v16, v15, s[16:19], s83 offen sc1
  s_mov_b64 exec, -1
L_t5:
  s_cmp_lt_u32 s62, 56
  s_cbranch_scc1 L_t8
  s_cmp_ge_u32 s61, 112
  s_cbranch_scc1 L_end
  v_lshlrev_b32 v76, 4, v0
  v_and_b32 v11, 1, v0
  v_cmp_eq_u32 s[84:85], 1, v11
  s_mul_i32 s80, s3, 896
  s_add_u32 s80, s80, 150528
  v_bfe_u32 v13, v0, 1, 3
  v_lshlrev_b32 v13, 2, v13
  v_add_u32 v13, v13, v3
  v_mul_u32_u24 v13, 28, v13
  v_lshl_add_u32 v77, v11, 4, v13
  v_add_u32 v77, s80, v77
  s_mov_b32 s82, 0x400000
  v_and_b32 v78, 7, v1
  v_mul_u32_u24 v78, 896, v78
  v_lshl_add_u32 v78, v3, 4, v78
  v_add_u32 v78, 150528, v78
  s_barrier
L_p3:
  buffer_load_dwordx4 v[16:19], v76, s[16:19], s82 offen sc1
  s_waitcnt vmcnt(0)
  v_cndmask_b32 v19, v19, 0, s[84:85]
  v_max3_u32 v13, v16, v17, v18
  v_max_u32 v13, v13, v19
  v_cmp_eq_u32 vcc, -1, v13
  v_lshlrev_b32 v24, 16, v16
  v_and_b32 v25, s86, v16
  v_lshlrev_b32 v26, 16, v17
  v_and_b32 v27, s86, v17
  v_lshlrev_b32 v28, 16, v18
  v_and_b32 v29, s86, v18
  v_lshlrev_b32 v30, 16, v19
  v_and_b32 v31, s86, v19
  s_cbranch_vccz L_p3_ok
  s_sub_u32 s88, s88, 1
  s_cmp_eq_u32 s88, 0
  s_cbranch_scc1 L_end
  s_branch L_p3
L_p3_ok:
  v_pk_add_f32 v[10:11], v[24:25], v[26:27]
  v_pk_add_f32 v[12:13], v[28:29], v[30:31]
  v_pk_add_f32 v[10:11], v[10:11], v[12:13]
  v_add_f32 v10, v10, v11
  s_nop 1
  v_add_f32_dpp v10, v10, v10 quad_perm:[1,0,3,2] row_mask:0xf bank_mask:0xf
  s_nop 1
  v_add_f32_dpp v10, v10, v10 quad_perm:[2,3,0,1] row_mask:0xf bank_mask:0xf
  s_nop 1
  v_add_f32_dpp v10, v10, v10 row_ror:4 row_mask:0xf bank_mask:0xf
  s_nop 1
  v_add_f32_dpp v10, v10, v10 row_ror:8 row_mask:0xf bank_mask:0xf
  v_mov_b32 v11, v10
  s_nop 1
  v_permlane16_swap_b32 v10, v11
  s_nop 0
  v_add_f32 v10, v10, v11
  v_mov_b32 v11, v10
  s_nop 1
  v_permlane32_swap_b32 v10, v11
  s_nop 0
  v_add_f32 v10, v10, v11
  v_mul_f32 v14, 0x3b124925, v10
  v_mul_f32 v15, 0x3b124925, v10
  v_pk_add_f32 v[24:25], v[24:25], v[14:15] neg_lo:[0,1] neg_hi:[0,1]
  v_pk_add_f32 v[26:27], v[26:27], v[14:15] neg_lo:[0,1] neg_hi:[0,1]
  v_pk_add_f32 v[28:29], v[28:29], v[14:15] neg_lo:[0,1] neg_hi:[0,1]
  v_pk_add_f32 v[30:31], v[30:31], v[14:15] neg_lo:[0,1] neg_hi:[0,1]
  v_cndmask_b32 v30, v30, 0, s[84:85]
  v_cndmask_b32 v31, v31, 0, s[84:85]
  v_pk_mul_f32 v[10:11], v[24:25], v[24:25]
  v_pk_mul_f32 v[12:13], v[26:27], v[26:27]
  v_pk_fma_f32 v[10:11], v[28:29], v[28:29], v[10:11]
  v_pk_fma_f32 v[12:13], v[30:31], v[30:31], v[12:13]
  v_pk_add_f32 v[10:11], v[10:11], v[12:13]
  v_add_f32 v10, v10, v11
  s_nop 1
  v_add_f32_dpp v10, v10, v10 quad_perm:[1,0,3,2] row_mask:0xf bank_mask:0xf
  s_nop 1
  v_add_f32_dpp v10, v10, v10 quad_perm:[2,3,0,1] row_mask:0xf bank_mask:0xf
  s_nop 1
  v_add_f32_dpp v10, v10, v10 row_ror:4 row_mask:0xf bank_mask:0xf
  s_nop 1
  v_add_f32_dpp v10, v10, v10 row_ror:8 row_mask:0xf bank_mask:0xf
  v_mov_b32 v11, v10
  s_nop 1
  v_permlane16_swap_b32 v10, v11
  s_nop 0
  v_add_f32 v10, v10, v11
  v_mov_b32 v11, v10
  s_nop 1
  v_permlane32_swap_b32 v10, v11
  s_nop 0
  v_add_f32 v10, v10, v11
  v_mul_f32 v10, 0x3b124925, v10
  v_cvt_pk_bf16_f32 v10, v10, v10
  v_lshlrev_b32 v10, 16, v10
  v_add_f32 v10, 0x3727c5ac, v10
  v_cvt_pk_bf16_f32 v10, v10, v10
  v_lshlrev_b32 v10, 16, v10
  v_sqrt_f32 v10, v10
  v_cvt_pk_bf16_f32 v14, v14, v14
  v_lshlrev_b32 v14, 16, v14
  v_cvt_pk_bf16_f32 v10, v10, v10
  v_lshlrev_b32 v10, 16, v10
  v_rcp_f32 v12, v10
  v_mov_b32 v15, v14
  v_mov_b32 v11, v10
  v_mov_b32 v13, v12
  v_lshlrev_b32 v32, 16, v16
  v_and_b32 v33, s86, v16
  v_pk_add_f32 v[32:33], v[32:33], v[14:15] neg_lo:[0,1] neg_hi:[0,1]
  v_cvt_pk_bf16_f32 v33, v32, v33
  v_lshlrev_b32 v32, 16, v33
  v_and_b32 v33, s86, v33
  v_pk_mul_f32 v[34:35], v[32:33], v[12:13]
  v_pk_fma_f32 v[36:37], v[34:35], v[10:11], v[32:33] neg_lo:[1,0,0] neg_hi:[1,0,0]
  v_pk_fma_f32 v[34:35], v[36:37], v[12:13], v[34:35]
  v_cvt_pk_bf16_f32 v16, v34, v35
  v_lshlrev_b32 v32, 16, v17
  v_and_b32 v33, s86, v17
  v_pk_add_f32 v[32:33], v[32:33], v[14:15] neg_lo:[0,1] neg_hi:[0,1]
  v_cvt_pk_bf16_f32 v33, v32, v33
  v_lshlrev_b32 v32, 16, v33
  v_and_b32 v33, s86, v33
  v_pk_mul_f32 v[34:35], v[32:33], v[12:13]
  v_pk_fma_f32 v[36:37], v[34:35], v[10:11], v[32:33] neg_lo:[1,0,0] neg_hi:[1,0,0]
  v_pk_fma_f32 v[34:35], v[36:37], v[12:13], v[34:35]
  v_cvt_pk_bf16_f32 v17, v34, v35
  v_lshlrev_b32 v32, 16, v18
  v_and_b32 v33, s86, v18
  v_pk_add_f32 v[32:33], v[32:33], v[14:15] neg_lo:[0,1] neg_hi:[0,1]
  v_cvt_pk_bf16_f32 v33, v32, v33
  v_lshlrev_b32 v32, 16, v33
  v_and_b32 v33, s86, v33
  v_pk_mul_f32 v[34:35], v[32:33], v[12:13]
  v_pk_fma_f32 v[36:37], v[34:35], v[10:11], v[32:33] neg_lo:[1,0,0] neg_hi:[1,0,0]
  v_pk_fma_f32 v[34:35], v[36:37], v[12:13], v[34:35]
  v_cvt_pk_bf16_f32 v18, v34, v35
  v_lshlrev_b32 v32, 16, v19
  v_and_b32 v33, s86, v19
  v_pk_add_f32 v[32:33], v[32:33], v[14:15] neg_lo:[0,1] neg_hi:[0,1]
  v_cvt_pk_bf16_f32 v33, v32, v33
  v_lshlrev_b32 v32, 16, v33
  v_and_b32 v33, s86, v33
  v_pk_mul_f32 v[34:35], v[32:33], v[12:13]
  v_pk_fma_f32 v[36:37], v[34:35], v[10:11], v[32:33] neg_lo:[1,0,0] neg_hi:[1,0,0]
  v_pk_fma_f32 v[34:35], v[36:37], v[12:13], v[34:35]
  v_cvt_pk_bf16_f32 v19, v34, v35
  ds_write2_b32 v77, v16, v17 offset0:0 offset1:1
  ds_write_b32 v77, v18 offset:8
  s_andn2_b64 exec, exec, s[84:85]
  ds_write_b32 v77, v19 offset:12
  s_mov_b64 exec, -1
  s_lshl_b32 s80, s61, 8
  s_add_u32 s80, s80, 0x410000
  v_lshlrev_b32 v10, 5, v2
  v_lshl_add_u32 v10, v3, 3, v10
  s_waitcnt lgkmcnt(0)
  s_barrier
  s_cmp_eq_u32 s3, 7
  s_cbranch_scc0 L_end
  ds_read_b128 v[16:19], v78 offset:0
  ds_read_b128 v[20:23], v78 offset:64
  ds_read_b128 v[24:27], v78 offset:128
  ds_read_b128 v[28:31], v78 offset:192
  ds_read_b128 v[32:35], v78 offset:256
  ds_read_b128 v[36:39], v78 offset:320
  ds_read_b128 v[40:43], v78 offset:384
  ds_read_b128 v[44:47], v78 offset:448
  ds_read_b128 v[48:51], v78 offset:512
  ds_read_b128 v[52:55], v78 offset:576
  ds_read_b128 v[56:59], v78 offset:640
  ds_read_b128 v[60:63], v78 offset:704
  ds_read_b128 v[64:67], v78 offset:768
  ds_read_b128 v[68:71], v78 offset:832
  s_waitcnt lgkmcnt(13)
  v_mfma_f32_16x16x32_bf16 v[80:83], v[128:131], v[16:19], 0
  v_mfma_f32_16x16x32_bf16 v[84:87], v[184:187], v[16:19], 0
  s_waitcnt lgkmcnt(12)
  v_mfma_f32_16x16x32_bf16 v[80:83], v[132:135], v[20:23], v[80:83]
  v_mfma_f32_16x16x32_bf16 v[84:87], v[188:191], v[20:23], v[84:87]
  s_waitcnt lgkmcnt(11)
  v_mfma_f32_16x16x32_bf16 v[80:83], v[136:139], v[24:27], v[80:83]
  v_mfma_f32_16x16x32_bf16 v[84:87], v[192:195], v[24:27], v[84:87]
  s_waitcnt lgkmcnt(10)
  v_mfma_f32_16x16x32_bf16 v[80:83], v[140:143], v[28:31], v[80:83]
  v_mfma_f32_16x16x32_bf16 v[84:87], v[196:199], v[28:31], v[84:87]
  s_waitcnt lgkmcnt(9)
  v_mfma_f32_16x16x32_bf16 v[80:83], v[144:147], v[32:35], v[80:83]
  v_mfma_f32_16x16x32_bf16 v[84:87], v[200:203], v[32:35], v[84:87]
  s_waitcnt lgkmcnt(8)
  v_mfma_f32_16x16x32_bf16 v[80:83], v[148:151], v[36:39], v[80:83]
  v_mfma_f32_16x16x32_bf16 v[84:87], v[204:207], v[36:39], v[84:87]
  s_waitcnt lgkmcnt(7)
  v_mfma_f32_16x16x32_bf16 v[80:83], v[152:155], v[40:43], v[80:83]
  v_mfma_f32_16x16x32_bf16 v[84:87], v[208:211], v[40:43], v[84:87]
  s_waitcnt lgkmcnt(6)
  v_mfma_f32_16x16x32_bf16 v[80:83], v[156:159], v[44:47], v[80:83]
  v_mfma_f32_16x16x32_bf16 v[84:87], v[212:215], v[44:47], v[84:87]
  s_waitcnt lgkmcnt(5)
  v_mfma_f32_16x16x32_bf16 v[80:83], v[160:163], v[48:51], v[80:83]
  v_mfma_f32_16x16x32_bf16 v[84:87], v[216:219], v[48:51], v[84:87]
  s_waitcnt lgkmcnt(4)
  v_mfma_f32_16x16x32_bf16 v[80:83], v[164:167], v[52:55], v[80:83]
  v_mfma_f32_16x16x32_bf16 v[84:87], v[220:223], v[52:55], v[84:87]
  s_waitcnt lgkmcnt(3)
  v_mfma_f32_16x16x32_bf16 v[80:83], v[168:171], v[56:59], v[80:83]
  v_mfma_f32_16x16x32_bf16 v[84:87], v[224:227], v[56:59], v[84:87]
  s_waitcnt lgkmcnt(2)
  v_mfma_f32_16x16x32_bf16 v[80:83], v[172:175], v[60:63], v[80:83]
  v_mfma_f32_16x16x32_bf16 v[84:87], v[228:231], v[60:63], v[84:87]
  s_waitcnt lgkmcnt(1)
  v_mfma_f32_16x16x32_bf16 v[80:83], v[176:179], v[64:67], v[80:83]
  v_mfma_f32_16x16x32_bf16 v[84:87], v[232:235], v[64:67], v[84:87]
  s_waitcnt lgkmcnt(0)
  v_mfma_f32_16x16x32_bf16 v[80:83], v[180:183], v[68:71], v[80:83]
  v_mfma_f32_16x16x32_bf16 v[84:87], v[236:239], v[68:71], v[84:87]
  s_mov_b32 exec_lo, 0x00ff00ff
  s_mov_b32 exec_hi, 0x00ff00ff
  s_nop 5
  v_cvt_pk_bf16_f32 v80, v80, v80
  v_lshlrev_b32 v80, 16, v80
  v_cvt_pk_bf16_f32 v81, v81, v81
  v_lshlrev_b32 v81, 16, v81
  v_cvt_pk_bf16_f32 v82, v82, v82
  v_lshlrev_b32 v82, 16, v82
  v_cvt_pk_bf16_f32 v83, v83, v83
  v_lshlrev_b32 v83, 16, v83
  v_cvt_pk_bf16_f32 v84, v84, v84
  v_lshlrev_b32 v84, 16, v84
  v_cvt_pk_bf16_f32 v85, v85, v85
  v_lshlrev_b32 v85, 16, v85
  v_cvt_pk_bf16_f32 v86, v86, v86
  v_lshlrev_b32 v86, 16, v86
  v_cvt_pk_bf16_f32 v87, v87, v87
  v_lshlrev_b32 v87, 16, v87
  v_pk_mul_f32 v[80:81], v[80:81], v[84:85]
  v_pk_mul_f32 v[82:83], v[82:83], v[86:87]
  v_cvt_pk_bf16_f32 v16, v80, v81
  v_cvt_pk_bf16_f32 v17, v82, v83
  v_min_u32 v16, 0xfffffffe, v16
  v_min_u32 v17, 0xfffffffe, v17
  buffer_store_dwordx2 v[16:17], v10, s[16:19], s80 offen sc1
  s_mov_b64 exec, -1
  s_branch L_end
L_t8:
  s_lshl_b32 s80, s62, 3
  v_and_b32 v12, 7, v1
  v_add_u32 v12, s80, v12
  v_mul_u32_u24 v13, 4682, v12
  v_lshrrev_b32 v13, 16, v13
  v_mul_u32_u24 v14, 14, v13
  v_sub_u32 v14, v12, v14
  v_and_b32 v76, 3, v13
  v_lshlrev_b32 v76, 3, v76
  v_lshrrev_b32 v13, 2, v13
  v_add_u32 v76, v76, v13
  v_lshlrev_b32 v76, 5, v76
  v_lshl_add_u32 v76, v14, 1, v76
  v_and_b32 v13, 1, v3
  v_lshl_add_u32 v76, v13, 12, v76
  s_mov_b32 s82, 0x400000
  v_and_b32 v10, 7, v1
  v_lshlrev_b32 v10, 5, v10
  v_lshrrev_b32 v11, 1, v3
  v_lshl_add_u32 v10, v11, 8, v10
  v_and_b32 v11, 1, v3
  v_lshl_add_u32 v10, v11, 4, v10
  s_mul_i32 s80, s3, 3584
  s_add_u32 s80, s80, 0x410000
  v_lshlrev_b32 v11, 4, v1
  s_lshl_b32 s81, s3, 9
  s_add_u32 s81, s81, 0
  v_add_u32 v11, s81, v11
  v_mul_u32_u24 v77, 3584, v3
  v_lshl_add_u32 v77, v12, 1, v77
  s_mov_b32 s20, s54
  s_and_b32 s21, s55, 0xffff
  s_mov_b32 s22, 7168
  s_mov_b32 s23, 0x20000
  s_cmp_eq_u32 s3, 0
  s_cbranch_scc0 L_ph_ok
  v_and_b32 v79, 0xfffffffc, v76
  v_and_b32 v78, 2, v76
  v_lshlrev_b32 v78, 3, v78
L_ph:
  buffer_load_dword v56, v79, s[16:19], s82 offen offset:0 sc1
  buffer_load_dword v57, v79, s[16:19], s82 offen offset:1024 sc1
  buffer_load_dword v58, v79, s[16:19], s82 offen offset:2048 sc1
  buffer_load_dword v59, v79, s[16:19], s82 offen offset:3072 sc1
  s_waitcnt vmcnt(0)
  v_max3_u32 v12, v56, v57, v58
  v_max_u32 v12, v12, v59
  v_cmp_eq_u32 vcc, -1, v12
  s_cbranch_vccz L_ph_ok
  s_sub_u32 s88, s88, 1
  s_cmp_eq_u32 s88, 0
  s_cbranch_scc1 L_end
  s_branch L_ph
L_ph_ok:
  s_barrier
L_p4:
  buffer_load_dwordx4 v[16:19], v10, s[16:19], s80 offen offset:0 sc1
  buffer_load_dwordx4 v[20:23], v10, s[16:19], s80 offen offset:512 sc1
  buffer_load_dwordx4 v[24:27], v10, s[16:19], s80 offen offset:1024 sc1
  buffer_load_dwordx4 v[28:31], v10, s[16:19], s80 offen offset:1536 sc1
  buffer_load_dwordx4 v[32:35], v10, s[16:19], s80 offen offset:2048 sc1
  buffer_load_dwordx4 v[36:39], v10, s[16:19], s80 offen offset:2560 sc1
  buffer_load_dwordx4 v[40:43], v10, s[16:19], s80 offen offset:3072 sc1
  s_waitcnt vmcnt(0)
  v_max3_u32 v12, v16, v17, v18
  v_max3_u32 v12, v12, v19, v20
  v_max3_u32 v12, v12, v21, v22
  v_max3_u32 v12, v12, v23, v24
  v_max3_u32 v12, v12, v25, v26
  v_max3_u32 v12, v12, v27, v28
  v_max3_u32 v12, v12, v29, v30
  v_max3_u32 v12, v12, v31, v32
  v_max3_u32 v12, v12, v33, v34
  v_max3_u32 v12, v12, v35, v36
  v_max3_u32 v12, v12, v37, v38
  v_max3_u32 v12, v12, v39, v40
  v_max3_u32 v12, v12, v41, v42
  v_max_u32 v12, v12, v43
  v_cmp_eq_u32 vcc, -1, v12
  s_cbranch_vccz L_p4_ok
  s_sub_u32 s88, s88, 1
  s_cmp_eq_u32 s88, 0
  s_cbranch_scc1 L_end
  s_branch L_p4
L_p4_ok:
  s_waitcnt lgkmcnt(0)
  v_mfma_f32_16x16x32_bf16 v[48:51], v[16:19], v[128:131], 0
  v_mfma_f32_16x16x32_bf16 v[48:51], v[20:23], v[132:135], v[48:51]
  v_mfma_f32_16x16x32_bf16 v[48:51], v[24:27], v[136:139], v[48:51]
  v_mfma_f32_16x16x32_bf16 v[48:51], v[28:31], v[140:143], v[48:51]
  v_mfma_f32_16x16x32_bf16 v[48:51], v[32:35], v[144:147], v[48:51]
  v_mfma_f32_16x16x32_bf16 v[48:51], v[36:39], v[148:151], v[48:51]
  v_mfma_f32_16x16x32_bf16 v[48:51], v[40:43], v[152:155], v[48:51]
  s_mov_b32 exec_hi, 0
  s_nop 7
  ds_write_b128 v11, v[48:51]
  s_mov_b64 exec, -1
  v_lshlrev_b32 v10, 4, v1
  s_waitcnt lgkmcnt(0)
  s_barrier
  s_cmp_eq_u32 s3, 0
  s_cbranch_scc0 L_end
  ds_read_b128 v[16:19], v10 offset:0
  ds_read_b128 v[20:23], v10 offset:512
  ds_read_b128 v[24:27], v10 offset:1024
  ds_read_b128 v[28:31], v10 offset:1536
  ds_read_b128 v[32:35], v10 offset:2048
  ds_read_b128 v[36:39], v10 offset:2560
  ds_read_b128 v[40:43], v10 offset:3072
  ds_read_b128 v[44:47], v10 offset:3584
  s_mov_b64 exec, 0x00ff00ff
  s_waitcnt lgkmcnt(0)
  v_pk_add_f32 v[16:17], v[16:17], v[20:21]
  v_pk_add_f32 v[18:19], v[18:19], v[22:23]
  v_pk_add_f32 v[16:17], v[16:17], v[24:25]
  v_pk_add_f32 v[18:19], v[18:19], v[26:27]
  v_pk_add_f32 v[16:17], v[16:17], v[28:29]
  v_pk_add_f32 v[18:19], v[18:19], v[30:31]
  v_pk_add_f32 v[16:17], v[16:17], v[32:33]
  v_pk_add_f32 v[18:19], v[18:19], v[34:35]
  v_pk_add_f32 v[16:17], v[16:17], v[36:37]
  v_pk_add_f32 v[18:19], v[18:19], v[38:39]
  v_pk_add_f32 v[16:17], v[16:17], v[40:41]
  v_pk_add_f32 v[18:19], v[18:19], v[42:43]
  v_pk_add_f32 v[16:17], v[16:17], v[44:45]
  v_pk_add_f32 v[18:19], v[18:19], v[46:47]
  v_cvt_pk_bf16_f32 v16, v16, v16
  v_lshlrev_b32 v16, 16, v16
  v_lshrrev_b32 v56, v78, v56
  v_lshlrev_b32 v56, 16, v56
  v_add_f32 v16, v16, v56
  v_cvt_pk_bf16_f32 v16, v16, v16
  buffer_store_short v16, v77, s[20:23], 0 offen offset:0
  v_cvt_pk_bf16_f32 v17, v17, v17
  v_lshlrev_b32 v17, 16, v17
  v_lshrrev_b32 v57, v78, v57
  v_lshlrev_b32 v57, 16, v57
  v_add_f32 v17, v17, v57
  v_cvt_pk_bf16_f32 v17, v17, v17
  buffer_store_short v17, v77, s[20:23], 0 offen offset:896
  v_cvt_pk_bf16_f32 v18, v18, v18
  v_lshlrev_b32 v18, 16, v18
  v_lshrrev_b32 v58, v78, v58
  v_lshlrev_b32 v58, 16, v58
  v_add_f32 v18, v18, v58
  v_cvt_pk_bf16_f32 v18, v18, v18
  buffer_store_short v18, v77, s[20:23], 0 offen offset:1792
  v_cvt_pk_bf16_f32 v19, v19, v19
  v_lshlrev_b32 v19, 16, v19
  v_lshrrev_b32 v59, v78, v59
  v_lshlrev_b32 v59, 16, v59
  v_add_f32 v19, v19, v59
  v_cvt_pk_bf16_f32 v19, v19, v19
  buffer_store_short v19, v77, s[20:23], 0 offen offset:2688
L_end:
  s_endpgm
.section .rodata,"a"
.p2align 6
.amdhsa_kernel sequential_preLN__gqa_block_cached__glu_gated_bilinear__decode_kernel
  .amdhsa_next_free_vgpr 256
  .amdhsa_next_free_sgpr 102
  .amdhsa_accum_offset 256
  .amdhsa_group_segment_fixed_size 0
  .amdhsa_kernarg_size 96
  .amdhsa_user_sgpr_count 2
  .amdhsa_user_sgpr_kernarg_segment_ptr 1
  .amdhsa_system_sgpr_workgroup_id_x 1
  .amdhsa_float_denorm_mode_32 3
.end_amdhsa_kernel
```
